```python
import torch

def _softmax(x, axis=-1):
    return torch.softmax(x, dim=axis)
def _gelu(x):
    return torch.nn.functional.gelu(x, approximate="tanh")
def _silu(x):
    return torch.nn.functional.silu(x)
def _sigmoid(x):
    return torch.sigmoid(x)
def _layernorm(x, axis=-1, eps=1e-5):
    m = x.mean(dim=axis, keepdim=True)
    v = x.var(dim=axis, keepdim=True, unbiased=False)
    return (x - m) / torch.sqrt(v + eps)
def _scatter_add(tgt, idx, src, axis=0):
    return tgt.clone().index_add_(axis, idx, src)
def _segment_sum(src, seg, n):
    out = torch.zeros((n,) + src.shape[1:], dtype=src.dtype)
    return out.index_add_(0, seg, src)
def _pad(x, pw):
    flat = tuple(v for pair in reversed(pw) for v in pair)
    return torch.nn.functional.pad(x, flat)

kernel_name = 'standalone__hybrid_graph_tf_graphgps__graph'

def setup_inputs():

    _w = (lambda a: (lambda t: t.to(torch.bfloat16) if t.is_floating_point() else t)(torch.as_tensor(a)))
    N, deg, D = 12500, 64, 64
    E = N * deg
    src = (lambda lo, hi, *s: torch.randint(lo, hi, s))(0, N, E).to(torch.int64)
    dst = (lambda lo, hi, *s: torch.randint(lo, hi, s))(0, N, E).to(torch.int64)
    deg_cnt = torch.bincount(dst, minlength=N).to(float) + 1.0
    sc = 1.0 / float(D) ** 0.5
    return {
        "x": _w((lambda *s: torch.randn(*s, dtype=torch.bfloat16) * 0.05)(N, D)),
        "src": _w(src),
        "dst": _w(dst),
        "deg_inv": _w((1.0 / deg_cnt).to(float)),
        "w_msg": _w((lambda *s: torch.randn(*s, dtype=torch.bfloat16) * 0.4)(D, D) * sc),
        "wq": _w((lambda *s: torch.randn(*s, dtype=torch.bfloat16) * 1.6)(D, D) * sc),
        "wk": _w((lambda *s: torch.randn(*s, dtype=torch.bfloat16) * 1.6)(D, D) * sc),
        "wv": _w((lambda *s: torch.randn(*s, dtype=torch.bfloat16) * 0.2)(D, D) * sc),
        "w_out": _w((lambda *s: torch.randn(*s, dtype=torch.bfloat16) * 0.2)(D, D) * sc),
    }

def reference(x, src, dst, deg_inv, w_msg, wq, wk, wv, w_out):
    N, D = x.shape[0], x.shape[1]
    h = _layernorm(x, axis=-1)
    m_e = torch.einsum('nd,de->ne', h, w_msg)
    h_local = _segment_sum(m_e[src], dst, N) * deg_inv[:, None]
    q = torch.einsum('nd,de->ne', h, wq)
    k = torch.einsum('nd,de->ne', h, wk)
    v = torch.einsum('nd,de->ne', h, wv)
    logits = torch.einsum('id,jd->ij', q, k) / (float(D) ** 0.5)
    attn = _softmax(logits, axis=-1)
    h_global = torch.einsum('ij,jd->id', attn, v)
    y = torch.einsum('nd,de->ne', h_local + h_global, w_out)
    return x + y
```

```asm
; @launch kernel=prep_kernel grid=(197,1,1) block=(256,1,1) lds=16384
; @launch kernel=attn_kernel grid=(245,1,1) block=(512,1,1) lds=147232
.amdgcn_target "amdgcn-amd-amdhsa--gfx950"
.text
.globl prep_kernel
.p2align 8
.type prep_kernel,@function
prep_kernel:
    s_cmp_ge_u32 s2, 197
    s_cbranch_scc1 K1_END
    s_load_dwordx16 s[16:31], s[0:1], 0
    s_load_dwordx8 s[32:39], s[0:1], 64
    s_cmp_eq_u32 s2, 196
    s_cbranch_scc1 K1_WPREP
    v_and_b32 v1, 15, v0
    v_bfe_u32 v2, v0, 4, 2
    v_lshrrev_b32 v3, 6, v0
    s_lshl_b32 s3, s2, 6
    v_lshlrev_b32 v4, 4, v3
    v_add3_u32 v4, v4, v1, s3
    v_lshlrev_b32 v5, 7, v4
    v_lshl_add_u32 v5, v2, 4, v5
    v_lshlrev_b32 v6, 4, v0
    s_waitcnt lgkmcnt(0)
    s_mov_b32 s4, s16
    s_mov_b32 s5, s17
    s_mov_b32 s6, 0x186a00
    s_mov_b32 s7, 0x00020000
    s_mov_b32 s8, s26
    s_mov_b32 s9, s27
    s_mov_b32 s10, 0x2000
    s_mov_b32 s11, 0x00020000
    s_mov_b32 s12, s28
    s_mov_b32 s13, s29
    s_mov_b32 s14, 0x2000
    s_mov_b32 s15, 0x00020000
    buffer_load_dwordx4 v[16:19], v5, s[4:7], 0 offen
    buffer_load_dwordx4 v[20:23], v5, s[4:7], 0 offen offset:64
    s_movk_i32 s40, 0x1000
    buffer_load_dwordx4 v[24:27], v6, s[8:11], 0 offen
    buffer_load_dwordx4 v[28:31], v6, s[8:11], s40 offen
    buffer_load_dwordx4 v[64:67], v6, s[12:15], 0 offen
    buffer_load_dwordx4 v[68:71], v6, s[12:15], s40 offen
    v_bfe_u32 v7, v0, 3, 3
    v_lshlrev_b32 v7, 4, v7
    v_xor_b32 v60, v6, v7
    v_lshrrev_b32 v7, 2, v1
    v_lshlrev_b32 v7, 3, v7
    v_and_b32 v8, 3, v1
    v_add_u32 v7, v7, v8
    v_lshlrev_b32 v7, 7, v7
    v_xor_b32 v8, v8, v2
    v_lshl_add_u32 v7, v8, 4, v7
    v_xor_b32 v61, 64, v7
    s_add_u32 s56, s38, 0x1280000
    s_addc_u32 s57, s39, 0
    s_mov_b32 s58, 0x850700
    s_mov_b32 s59, 0x00020000
    s_mul_i32 s41, s2, 35584
    v_lshlrev_b32 v8, 2, v0
    v_add_u32 v8, s41, v8
    v_mov_b32 v9, 0
    buffer_store_dword v9, v8, s[56:59], 0 offen sc0 sc1
    v_add_u32 v8, 6974464, v8
    buffer_store_dword v9, v8, s[56:59], 0 offen sc0 sc1
    s_getpc_b64 s[60:61]
K1_PC:
    s_add_u32 s60, s60, attn_kernel-K1_PC
    s_addc_u32 s61, s61, 0
    v_lshlrev_b32 v8, 7, v0
    v_min_u32 v8, K2_END-attn_kernel, v8
    global_load_dword v63, v8, s[60:61]
    s_mov_b32 s44, s38
    s_mov_b32 s45, s39
    s_mov_b32 s46, 0x187000
    s_mov_b32 s47, 0x00020000
    s_add_u32 s48, s38, 0x190000
    s_addc_u32 s49, s39, 0
    s_mov_b32 s50, 0x187000
    s_mov_b32 s51, 0x00020000
    s_add_u32 s52, s38, 0x320000
    s_addc_u32 s53, s39, 0
    s_mov_b32 s54, 0x187000
    s_mov_b32 s55, 0x00020000
    v_bfe_u32 v8, v4, 1, 1
    v_lshlrev_b32 v8, 2, v8
    v_bfe_u32 v9, v4, 2, 2
    v_or_b32 v8, v8, v9
    v_xor_b32 v9, v2, v8
    v_xor_b32 v10, 4, v9
    v_lshlrev_b32 v11, 7, v4
    v_lshl_add_u32 v9, v9, 4, v11
    v_lshl_add_u32 v10, v10, 4, v11
    v_lshrrev_b32 v11, 5, v4
    v_lshlrev_b32 v11, 12, v11
    v_and_b32 v12, 31, v4
    v_lshl_add_u32 v11, v12, 4, v11
    v_lshrrev_b32 v12, 1, v2
    v_lshl_add_u32 v11, v12, 10, v11
    v_and_b32 v12, 1, v2
    v_lshl_add_u32 v11, v12, 9, v11
    v_bfe_u32 v12, v0, 2, 2
    v_lshl_add_u32 v12, v2, 3, v12
    v_lshlrev_b32 v12, 7, v12
    v_and_b32 v13, 3, v0
    v_lshl_add_u32 v12, v13, 4, v12
    v_mov_b32 v14, 0x3f800000
    v_cmp_gt_u32 vcc, 12500, v4
    s_nop 1
    v_cndmask_b32 v14, 0, v14, vcc
    s_waitcnt vmcnt(5)
    ds_write_b128 v6, v[24:27]
    ds_write_b128 v6, v[28:31] offset:4096
    v_lshlrev_b32 v32, 16, v16
    v_and_b32 v33, 0xffff0000, v16
    v_lshlrev_b32 v34, 16, v17
    v_and_b32 v35, 0xffff0000, v17
    v_lshlrev_b32 v36, 16, v18
    v_and_b32 v37, 0xffff0000, v18
    v_lshlrev_b32 v38, 16, v19
    v_and_b32 v39, 0xffff0000, v19
    v_lshlrev_b32 v40, 16, v20
    v_and_b32 v41, 0xffff0000, v20
    v_lshlrev_b32 v42, 16, v21
    v_and_b32 v43, 0xffff0000, v21
    v_lshlrev_b32 v44, 16, v22
    v_and_b32 v45, 0xffff0000, v22
    v_lshlrev_b32 v46, 16, v23
    v_and_b32 v47, 0xffff0000, v23
    s_waitcnt vmcnt(3)
    ds_write_b128 v60, v[64:67] offset:8192
    ds_write_b128 v60, v[68:71] offset:12288
    s_waitcnt lgkmcnt(0)
    s_barrier
    ds_read_b64_tr_b16 v[96:97], v12 offset:0
    ds_read_b64_tr_b16 v[98:99], v12 offset:512
    ds_read_b64_tr_b16 v[100:101], v12 offset:4096
    ds_read_b64_tr_b16 v[102:103], v12 offset:4608
    ds_read_b64_tr_b16 v[104:105], v12 offset:8
    ds_read_b64_tr_b16 v[106:107], v12 offset:520
    ds_read_b64_tr_b16 v[108:109], v12 offset:4104
    ds_read_b64_tr_b16 v[110:111], v12 offset:4616
    ds_read_b64_tr_b16 v[112:113], v12 offset:64
    ds_read_b64_tr_b16 v[114:115], v12 offset:576
    ds_read_b64_tr_b16 v[116:117], v12 offset:4160
    ds_read_b64_tr_b16 v[118:119], v12 offset:4672
    ds_read_b64_tr_b16 v[120:121], v12 offset:72
    ds_read_b64_tr_b16 v[122:123], v12 offset:584
    ds_read_b64_tr_b16 v[124:125], v12 offset:4168
    ds_read_b64_tr_b16 v[126:127], v12 offset:4680
    ds_read_b128 v[64:67], v7 offset:8192
    ds_read_b128 v[68:71], v61 offset:8192
    ds_read_b128 v[72:75], v61 offset:8704
    ds_read_b128 v[76:79], v7 offset:8704
    ds_read_b128 v[80:83], v7 offset:12288
    ds_read_b128 v[84:87], v61 offset:12288
    ds_read_b128 v[88:91], v61 offset:12800
    ds_read_b128 v[92:95], v7 offset:12800
    v_add_f32 v48, v32, v33
    v_add_f32 v49, v34, v35
    v_add_f32 v48, v48, v36
    v_add_f32 v49, v49, v37
    v_add_f32 v48, v48, v38
    v_add_f32 v49, v49, v39
    v_add_f32 v48, v48, v40
    v_add_f32 v49, v49, v41
    v_add_f32 v48, v48, v42
    v_add_f32 v49, v49, v43
    v_add_f32 v48, v48, v44
    v_add_f32 v49, v49, v45
    v_add_f32 v48, v48, v46
    v_add_f32 v49, v49, v47
    v_add_f32 v48, v48, v49
    v_mov_b32 v49, v48
    s_nop 1
    v_permlane16_swap_b32 v48, v49
    v_add_f32 v48, v48, v49
    v_mov_b32 v49, v48
    s_nop 1
    v_permlane32_swap_b32 v48, v49
    v_add_f32 v48, v48, v49
    v_mul_f32 v48, 0x3c800000, v48
    v_sub_f32 v32, v32, v48
    v_sub_f32 v33, v33, v48
    v_sub_f32 v34, v34, v48
    v_sub_f32 v35, v35, v48
    v_sub_f32 v36, v36, v48
    v_sub_f32 v37, v37, v48
    v_sub_f32 v38, v38, v48
    v_sub_f32 v39, v39, v48
    v_sub_f32 v40, v40, v48
    v_sub_f32 v41, v41, v48
    v_sub_f32 v42, v42, v48
    v_sub_f32 v43, v43, v48
    v_sub_f32 v44, v44, v48
    v_sub_f32 v45, v45, v48
    v_sub_f32 v46, v46, v48
    v_sub_f32 v47, v47, v48
    v_mul_f32 v48, v32, v32
    v_mul_f32 v49, v33, v33
    v_fmac_f32 v48, v34, v34
    v_fmac_f32 v49, v35, v35
    v_fmac_f32 v48, v36, v36
    v_fmac_f32 v49, v37, v37
    v_fmac_f32 v48, v38, v38
    v_fmac_f32 v49, v39, v39
    v_fmac_f32 v48, v40, v40
    v_fmac_f32 v49, v41, v41
    v_fmac_f32 v48, v42, v42
    v_fmac_f32 v49, v43, v43
    v_fmac_f32 v48, v44, v44
    v_fmac_f32 v49, v45, v45
    v_fmac_f32 v48, v46, v46
    v_fmac_f32 v49, v47, v47
    v_add_f32 v48, v48, v49
    v_mov_b32 v49, v48
    s_nop 1
    v_permlane16_swap_b32 v48, v49
    v_add_f32 v48, v48, v49
    v_mov_b32 v49, v48
    s_nop 1
    v_permlane32_swap_b32 v48, v49
    v_add_f32 v48, v48, v49
    s_mov_b32 s41, 0x3c800000
    v_mov_b32 v49, 0x3727c5ac
    v_fma_f32 v48, v48, s41, v49
    v_rsq_f32 v48, v48
    s_mov_b32 s41, 0x3b2a00aa
    v_mov_b32 v49, 0x3caa00aa
    v_mul_f32 v32, v32, v48
    v_mul_f32 v33, v33, v48
    v_mul_f32 v34, v34, v48
    v_mul_f32 v35, v35, v48
    v_mul_f32 v36, v36, v48
    v_mul_f32 v37, v37, v48
    v_mul_f32 v38, v38, v48
    v_mul_f32 v39, v39, v48
    v_mul_f32 v40, v40, v48
    v_mul_f32 v41, v41, v48
    v_mul_f32 v42, v42, v48
    v_mul_f32 v43, v43, v48
    v_mul_f32 v44, v44, v48
    v_mul_f32 v45, v45, v48
    v_mul_f32 v46, v46, v48
    v_mul_f32 v47, v47, v48
    v_cvt_pk_bf16_f32 v16, v32, v33
    v_cvt_pk_bf16_f32 v17, v34, v35
    v_cvt_pk_bf16_f32 v18, v36, v37
    v_cvt_pk_bf16_f32 v19, v38, v39
    v_cvt_pk_bf16_f32 v20, v40, v41
    v_cvt_pk_bf16_f32 v21, v42, v43
    v_cvt_pk_bf16_f32 v22, v44, v45
    v_cvt_pk_bf16_f32 v23, v46, v47
    v_fma_f32 v32, v32, s41, v49
    v_fma_f32 v33, v33, s41, v49
    v_fma_f32 v34, v34, s41, v49
    v_fma_f32 v35, v35, s41, v49
    v_fma_f32 v36, v36, s41, v49
    v_fma_f32 v37, v37, s41, v49
    v_fma_f32 v38, v38, s41, v49
    v_fma_f32 v39, v39, s41, v49
    v_fma_f32 v40, v40, s41, v49
    v_fma_f32 v41, v41, s41, v49
    v_fma_f32 v42, v42, s41, v49
    v_fma_f32 v43, v43, s41, v49
    v_fma_f32 v44, v44, s41, v49
    v_fma_f32 v45, v45, s41, v49
    v_fma_f32 v46, v46, s41, v49
    v_fma_f32 v47, v47, s41, v49
    v_cvt_pknorm_u16_f32 v24, v32, v33
    v_cvt_pknorm_u16_f32 v25, v34, v35
    v_cvt_pknorm_u16_f32 v26, v36, v37
    v_cvt_pknorm_u16_f32 v27, v38, v39
    v_cvt_pknorm_u16_f32 v28, v40, v41
    v_cvt_pknorm_u16_f32 v29, v42, v43
    v_cvt_pknorm_u16_f32 v30, v44, v45
    v_cvt_pknorm_u16_f32 v31, v46, v47
    s_waitcnt lgkmcnt(0)
    v_mfma_f32_16x16x32_bf16 v[32:35], v[96:99], v[16:19], 0
    v_mfma_f32_16x16x32_bf16 v[36:39], v[104:107], v[16:19], 0
    v_mfma_f32_16x16x32_bf16 v[40:43], v[112:115], v[16:19], 0
    v_mfma_f32_16x16x32_bf16 v[44:47], v[120:123], v[16:19], 0
    v_mfma_f32_16x16x32_bf16 v[32:35], v[100:103], v[20:23], v[32:35]
    v_mfma_f32_16x16x32_bf16 v[36:39], v[108:111], v[20:23], v[36:39]
    v_mfma_f32_16x16x32_bf16 v[40:43], v[116:119], v[20:23], v[40:43]
    v_mfma_f32_16x16x32_bf16 v[44:47], v[124:127], v[20:23], v[44:47]
    buffer_store_dwordx4 v[24:27], v5, s[52:55], 0 offen sc0 sc1
    buffer_store_dwordx4 v[28:31], v5, s[52:55], 0 offen offset:64 sc0 sc1
    buffer_store_dwordx4 v[16:19], v9, s[44:47], 0 offen sc0 sc1
    v_and_b32 v50, 0xffff, v23
    v_or_b32 v50, v50, v14
    v_cmp_eq_u32 vcc, 3, v2
    s_nop 1
    v_cndmask_b32 v23, v23, v50, vcc
    buffer_store_dwordx4 v[20:23], v10, s[44:47], 0 offen sc0 sc1
    v_cvt_pk_bf16_f32 v52, v32, v33
    v_cvt_pk_bf16_f32 v53, v34, v35
    v_cvt_pk_bf16_f32 v54, v36, v37
    v_cvt_pk_bf16_f32 v55, v38, v39
    v_cvt_pk_bf16_f32 v56, v40, v41
    v_cvt_pk_bf16_f32 v57, v42, v43
    v_cvt_pk_bf16_f32 v58, v44, v45
    v_cvt_pk_bf16_f32 v59, v46, v47
    v_mfma_f32_16x16x32_bf16 v[96:99], v[64:67], v[52:55], 0
    v_mfma_f32_16x16x32_bf16 v[100:103], v[72:75], v[52:55], 0
    v_mfma_f32_16x16x32_bf16 v[104:107], v[80:83], v[52:55], 0
    v_mfma_f32_16x16x32_bf16 v[108:111], v[88:91], v[52:55], 0
    v_mfma_f32_16x16x32_bf16 v[96:99], v[68:71], v[56:59], v[96:99]
    v_mfma_f32_16x16x32_bf16 v[100:103], v[76:79], v[56:59], v[100:103]
    v_mfma_f32_16x16x32_bf16 v[104:107], v[84:87], v[56:59], v[104:107]
    v_mfma_f32_16x16x32_bf16 v[108:111], v[92:95], v[56:59], v[108:111]
    s_nop 4
    v_mul_f32 v48, v96, v96
    v_mul_f32 v49, v97, v97
    v_fmac_f32 v48, v98, v98
    v_fmac_f32 v49, v99, v99
    v_fmac_f32 v48, v100, v100
    v_fmac_f32 v49, v101, v101
    v_fmac_f32 v48, v102, v102
    v_fmac_f32 v49, v103, v103
    v_fmac_f32 v48, v104, v104
    v_fmac_f32 v49, v105, v105
    v_fmac_f32 v48, v106, v106
    v_fmac_f32 v49, v107, v107
    v_fmac_f32 v48, v108, v108
    v_fmac_f32 v49, v109, v109
    v_fmac_f32 v48, v110, v110
    v_fmac_f32 v49, v111, v111
    v_add_f32 v48, v48, v49
    v_cndmask_b32 v50, 0, v111, vcc
    v_mov_b32 v49, v48
    s_nop 1
    v_permlane16_swap_b32 v48, v49
    v_add_f32 v48, v48, v49
    v_mov_b32 v51, v50
    s_nop 1
    v_permlane16_swap_b32 v50, v51
    v_add_f32 v50, v50, v51
    v_mov_b32 v49, v48
    s_nop 1
    v_permlane32_swap_b32 v48, v49
    v_add_f32 v48, v48, v49
    v_mov_b32 v51, v50
    s_nop 1
    v_permlane32_swap_b32 v50, v51
    v_add_f32 v50, v50, v51
    v_sqrt_f32 v48, v48
    s_mov_b32 s41, 0x3e38aa3b
    s_mov_b32 s42, 0xbfbaf929
    v_mov_b32 v49, 0x42800000
    v_mul_f32 v50, s41, v50
    v_fma_f32 v48, v48, s42, v49
    v_fma_f32 v96, v96, s41, -v50
    v_fma_f32 v97, v97, s41, -v50
    v_fma_f32 v98, v98, s41, -v50
    v_fma_f32 v99, v99, s41, -v50
    v_fma_f32 v100, v100, s41, -v50
    v_fma_f32 v101, v101, s41, -v50
    v_fma_f32 v102, v102, s41, -v50
    v_fma_f32 v103, v103, s41, -v50
    v_fma_f32 v104, v104, s41, -v50
    v_fma_f32 v105, v105, s41, -v50
    v_fma_f32 v106, v106, s41, -v50
    v_fma_f32 v107, v107, s41, -v50
    v_fma_f32 v108, v108, s41, -v50
    v_fma_f32 v109, v109, s41, -v50
    v_fma_f32 v110, v110, s41, -v50
    v_fma_f32 v111, v111, s41, -v50
    v_cndmask_b32 v111, v111, v48, vcc
    v_cvt_pk_bf16_f32 v52, v96, v97
    v_cvt_pk_bf16_f32 v53, v98, v99
    v_cvt_pk_bf16_f32 v54, v100, v101
    v_cvt_pk_bf16_f32 v55, v102, v103
    v_cvt_pk_bf16_f32 v56, v104, v105
    v_cvt_pk_bf16_f32 v57, v106, v107
    v_cvt_pk_bf16_f32 v58, v108, v109
    v_cvt_pk_bf16_f32 v59, v110, v111
    buffer_store_dwordx4 v[52:55], v11, s[48:51], 0 offen sc0 sc1
    buffer_store_dwordx4 v[56:59], v11, s[48:51], 0 offen offset:2048 sc0 sc1
    s_endpgm
K1_WPREP:
    v_lshrrev_b32 v3, 6, v0
    v_and_b32 v1, 63, v0
    v_readfirstlane_b32 s3, v3
    v_lshlrev_b32 v6, 4, v0
    s_waitcnt lgkmcnt(0)
    s_mov_b32 s4, s32
    s_mov_b32 s5, s33
    s_mov_b32 s6, 0x2000
    s_mov_b32 s7, 0x00020000
    s_add_u32 s44, s38, 0x644000
    s_addc_u32 s45, s39, 0
    s_mov_b32 s46, 0x3100
    s_mov_b32 s47, 0x00020000
    v_lshlrev_b32 v2, 8, v0
    v_mov_b32 v4, 0
    buffer_store_dword v4, v2, s[44:47], 0 offen sc0 sc1
    s_movk_i32 s40, 0x1000
    buffer_load_dwordx4 v[24:27], v6, s[4:7], 0 offen
    buffer_load_dwordx4 v[28:31], v6, s[4:7], s40 offen
    s_cmp_ge_u32 s3, 2
    s_cselect_b32 s8, s24, s30
    s_cselect_b32 s9, s25, s31
    s_cselect_b64 vcc, -1, 0
    s_mov_b32 s10, 8192
    s_mov_b32 s11, 0x00020000
    s_and_b32 s41, s3, 1
    s_lshl_b32 s41, s41, 12
    v_and_b32 v2, 31, v0
    v_lshrrev_b32 v4, 5, v1
    v_and_b32 v7, 0x13, v2
    v_bfe_u32 v8, v2, 2, 1
    v_lshl_or_b32 v7, v8, 3, v7
    v_bfe_u32 v8, v2, 3, 1
    v_lshl_or_b32 v7, v8, 2, v7
    v_cndmask_b32 v7, v2, v7, vcc
    v_lshlrev_b32 v7, 7, v7
    v_lshl_add_u32 v7, v4, 4, v7
    v_lshlrev_b32 v8, 4, v4
    v_add_u32 v8, 8064, v8
    buffer_load_dwordx4 v[32:35], v7, s[8:11], s41 offen offset:0
    buffer_load_dwordx4 v[36:39], v7, s[8:11], s41 offen offset:32
    buffer_load_dwordx4 v[40:43], v7, s[8:11], s41 offen offset:64
    buffer_load_dwordx4 v[44:47], v7, s[8:11], s41 offen offset:96
    buffer_load_dwordx4 v[48:51], v8, s[8:11], 0 offen offset:0
    buffer_load_dwordx4 v[52:55], v8, s[8:11], 0 offen offset:32
    buffer_load_dwordx4 v[56:59], v8, s[8:11], 0 offen offset:64
    buffer_load_dwordx4 v[60:63], v8, s[8:11], 0 offen offset:96
    v_bfe_u32 v9, v0, 2, 2
    v_lshl_add_u32 v9, v4, 3, v9
    v_lshlrev_b32 v9, 7, v9
    v_bfe_u32 v10, v0, 4, 1
    v_lshl_add_u32 v9, v10, 5, v9
    v_and_b32 v10, 1, v0
    v_lshl_add_u32 v9, v10, 4, v9
    v_bfe_u32 v10, v0, 1, 1
    v_lshl_add_u32 v9, v10, 3, v9
    s_waitcnt vmcnt(8)
    ds_write_b128 v6, v[24:27]
    ds_write_b128 v6, v[28:31] offset:4096
    s_waitcnt lgkmcnt(0)
    s_barrier
    ds_read_b64_tr_b16 v[64:65], v9 offset:0
    ds_read_b64_tr_b16 v[66:67], v9 offset:512
    ds_read_b64_tr_b16 v[68:69], v9 offset:2048
    ds_read_b64_tr_b16 v[70:71], v9 offset:2560
    ds_read_b64_tr_b16 v[72:73], v9 offset:4096
    ds_read_b64_tr_b16 v[74:75], v9 offset:4608
    ds_read_b64_tr_b16 v[76:77], v9 offset:6144
    ds_read_b64_tr_b16 v[78:79], v9 offset:6656
    ds_read_b64_tr_b16 v[80:81], v9 offset:64
    ds_read_b64_tr_b16 v[82:83], v9 offset:576
    ds_read_b64_tr_b16 v[84:85], v9 offset:2112
    ds_read_b64_tr_b16 v[86:87], v9 offset:2624
    ds_read_b64_tr_b16 v[88:89], v9 offset:4160
    ds_read_b64_tr_b16 v[90:91], v9 offset:4672
    ds_read_b64_tr_b16 v[92:93], v9 offset:6208
    ds_read_b64_tr_b16 v[94:95], v9 offset:6720
    s_waitcnt vmcnt(0)
    s_cbranch_vccnz K1_NOSUB
    v_lshlrev_b32 v10, 16, v32
    v_and_b32 v11, 0xffff0000, v32
    v_lshlrev_b32 v12, 16, v48
    v_and_b32 v13, 0xffff0000, v48
    v_sub_f32 v10, v10, v12
    v_sub_f32 v11, v11, v13
    v_cvt_pk_bf16_f32 v32, v10, v11
    v_lshlrev_b32 v10, 16, v33
    v_and_b32 v11, 0xffff0000, v33
    v_lshlrev_b32 v12, 16, v49
    v_and_b32 v13, 0xffff0000, v49
    v_sub_f32 v10, v10, v12
    v_sub_f32 v11, v11, v13
    v_cvt_pk_bf16_f32 v33, v10, v11
    v_lshlrev_b32 v10, 16, v34
    v_and_b32 v11, 0xffff0000, v34
    v_lshlrev_b32 v12, 16, v50
    v_and_b32 v13, 0xffff0000, v50
    v_sub_f32 v10, v10, v12
    v_sub_f32 v11, v11, v13
    v_cvt_pk_bf16_f32 v34, v10, v11
    v_lshlrev_b32 v10, 16, v35
    v_and_b32 v11, 0xffff0000, v35
    v_lshlrev_b32 v12, 16, v51
    v_and_b32 v13, 0xffff0000, v51
    v_sub_f32 v10, v10, v12
    v_sub_f32 v11, v11, v13
    v_cvt_pk_bf16_f32 v35, v10, v11
    v_lshlrev_b32 v10, 16, v36
    v_and_b32 v11, 0xffff0000, v36
    v_lshlrev_b32 v12, 16, v52
    v_and_b32 v13, 0xffff0000, v52
    v_sub_f32 v10, v10, v12
    v_sub_f32 v11, v11, v13
    v_cvt_pk_bf16_f32 v36, v10, v11
    v_lshlrev_b32 v10, 16, v37
    v_and_b32 v11, 0xffff0000, v37
    v_lshlrev_b32 v12, 16, v53
    v_and_b32 v13, 0xffff0000, v53
    v_sub_f32 v10, v10, v12
    v_sub_f32 v11, v11, v13
    v_cvt_pk_bf16_f32 v37, v10, v11
    v_lshlrev_b32 v10, 16, v38
    v_and_b32 v11, 0xffff0000, v38
    v_lshlrev_b32 v12, 16, v54
    v_and_b32 v13, 0xffff0000, v54
    v_sub_f32 v10, v10, v12
    v_sub_f32 v11, v11, v13
    v_cvt_pk_bf16_f32 v38, v10, v11
    v_lshlrev_b32 v10, 16, v39
    v_and_b32 v11, 0xffff0000, v39
    v_lshlrev_b32 v12, 16, v55
    v_and_b32 v13, 0xffff0000, v55
    v_sub_f32 v10, v10, v12
    v_sub_f32 v11, v11, v13
    v_cvt_pk_bf16_f32 v39, v10, v11
    v_lshlrev_b32 v10, 16, v40
    v_and_b32 v11, 0xffff0000, v40
    v_lshlrev_b32 v12, 16, v56
    v_and_b32 v13, 0xffff0000, v56
    v_sub_f32 v10, v10, v12
    v_sub_f32 v11, v11, v13
    v_cvt_pk_bf16_f32 v40, v10, v11
    v_lshlrev_b32 v10, 16, v41
    v_and_b32 v11, 0xffff0000, v41
    v_lshlrev_b32 v12, 16, v57
    v_and_b32 v13, 0xffff0000, v57
    v_sub_f32 v10, v10, v12
    v_sub_f32 v11, v11, v13
    v_cvt_pk_bf16_f32 v41, v10, v11
    v_lshlrev_b32 v10, 16, v42
    v_and_b32 v11, 0xffff0000, v42
    v_lshlrev_b32 v12, 16, v58
    v_and_b32 v13, 0xffff0000, v58
    v_sub_f32 v10, v10, v12
    v_sub_f32 v11, v11, v13
    v_cvt_pk_bf16_f32 v42, v10, v11
    v_lshlrev_b32 v10, 16, v43
    v_and_b32 v11, 0xffff0000, v43
    v_lshlrev_b32 v12, 16, v59
    v_and_b32 v13, 0xffff0000, v59
    v_sub_f32 v10, v10, v12
    v_sub_f32 v11, v11, v13
    v_cvt_pk_bf16_f32 v43, v10, v11
    v_lshlrev_b32 v10, 16, v44
    v_and_b32 v11, 0xffff0000, v44
    v_lshlrev_b32 v12, 16, v60
    v_and_b32 v13, 0xffff0000, v60
    v_sub_f32 v10, v10, v12
    v_sub_f32 v11, v11, v13
    v_cvt_pk_bf16_f32 v44, v10, v11
    v_lshlrev_b32 v10, 16, v45
    v_and_b32 v11, 0xffff0000, v45
    v_lshlrev_b32 v12, 16, v61
    v_and_b32 v13, 0xffff0000, v61
    v_sub_f32 v10, v10, v12
    v_sub_f32 v11, v11, v13
    v_cvt_pk_bf16_f32 v45, v10, v11
    v_lshlrev_b32 v10, 16, v46
    v_and_b32 v11, 0xffff0000, v46
    v_lshlrev_b32 v12, 16, v62
    v_and_b32 v13, 0xffff0000, v62
    v_sub_f32 v10, v10, v12
    v_sub_f32 v11, v11, v13
    v_cvt_pk_bf16_f32 v46, v10, v11
    v_lshlrev_b32 v10, 16, v47
    v_and_b32 v11, 0xffff0000, v47
    v_lshlrev_b32 v12, 16, v63
    v_and_b32 v13, 0xffff0000, v63
    v_sub_f32 v10, v10, v12
    v_sub_f32 v11, v11, v13
    v_cvt_pk_bf16_f32 v47, v10, v11
K1_NOSUB:
    s_waitcnt lgkmcnt(0)
    s_nop 1
    v_mfma_f32_32x32x16_bf16 v[96:111], v[32:35], v[64:67], 0
    v_mfma_f32_32x32x16_bf16 v[96:111], v[36:39], v[68:71], v[96:111]
    v_mfma_f32_32x32x16_bf16 v[96:111], v[40:43], v[72:75], v[96:111]
    v_mfma_f32_32x32x16_bf16 v[96:111], v[44:47], v[76:79], v[96:111]
    v_mfma_f32_32x32x16_bf16 v[112:127], v[32:35], v[80:83], 0
    v_mfma_f32_32x32x16_bf16 v[112:127], v[36:39], v[84:87], v[112:127]
    v_mfma_f32_32x32x16_bf16 v[112:127], v[40:43], v[88:91], v[112:127]
    v_mfma_f32_32x32x16_bf16 v[112:127], v[44:47], v[92:95], v[112:127]
    s_lshr_b32 s42, s3, 1
    s_lshl_b32 s42, s42, 13
    s_add_u32 s42, s42, 0x640000
    s_add_u32 s12, s38, s42
    s_addc_u32 s13, s39, 0
    s_mov_b32 s14, 0x2000
    s_mov_b32 s15, 0x00020000
    s_lshr_b32 s41, s41, 1
    v_lshlrev_b32 v6, 4, v1
    s_add_u32 s43, s41, 0x1000
    v_cvt_pk_bf16_f32 v32, v96, v97
    v_cvt_pk_bf16_f32 v33, v98, v99
    v_cvt_pk_bf16_f32 v34, v100, v101
    v_cvt_pk_bf16_f32 v35, v102, v103
    v_cvt_pk_bf16_f32 v36, v104, v105
    v_cvt_pk_bf16_f32 v37, v106, v107
    v_cvt_pk_bf16_f32 v38, v108, v109
    v_cvt_pk_bf16_f32 v39, v110, v111
    buffer_store_dwordx4 v[32:35], v6, s[12:15], s41 offen offset:0 sc0 sc1
    buffer_store_dwordx4 v[36:39], v6, s[12:15], s41 offen offset:1024 sc0 sc1
    v_cvt_pk_bf16_f32 v40, v112, v113
    v_cvt_pk_bf16_f32 v41, v114, v115
    v_cvt_pk_bf16_f32 v42, v116, v117
    v_cvt_pk_bf16_f32 v43, v118, v119
    v_cvt_pk_bf16_f32 v44, v120, v121
    v_cvt_pk_bf16_f32 v45, v122, v123
    v_cvt_pk_bf16_f32 v46, v124, v125
    v_cvt_pk_bf16_f32 v47, v126, v127
    buffer_store_dwordx4 v[40:43], v6, s[12:15], s43 offen offset:0 sc0 sc1
    buffer_store_dwordx4 v[44:47], v6, s[12:15], s43 offen offset:1024 sc0 sc1
K1_END:
    s_endpgm
.globl attn_kernel
.p2align 8
.type attn_kernel,@function
attn_kernel:
    s_cmp_ge_u32 s2, 245
    s_cbranch_scc1 K2_END
    s_load_dwordx2 s[4:5], s[0:1], 88
    s_load_dwordx2 s[6:7], s[0:1], 24
    s_load_dwordx4 s[96:99], s[0:1], 72
    s_load_dwordx2 s[100:101], s[0:1], 0
    s_load_dwordx4 s[92:95], s[0:1], 8
    v_lshrrev_b32 v1, 6, v0
    s_and_b32 s66, s2, 7
    s_lshr_b32 s67, s2, 3
    v_readfirstlane_b32 s3, v1
    s_mul_i32 s8, s67, 52
    s_lshr_b32 s8, s8, 8
    s_mul_i32 s9, s8, 5
    s_sub_u32 s9, s67, s9
    s_lshl_b32 s8, s8, 3
    s_add_u32 s8, s8, s66
    s_cmp_ge_u32 s2, 240
    s_cselect_b32 s8, 48, s8
    s_cselect_b32 s9, s66, s9
    s_lshl_b32 s64, s8, 2
    s_add_u32 s64, s64, s9
    s_mul_i32 s10, s9, 77
    s_cmp_eq_u32 s9, 4
    s_cselect_b32 s64, 255, s64
    s_movk_i32 s11, 77
    s_cselect_b32 s11, 83, s11
    s_cmp_ge_u32 s3, 4
    s_cbranch_scc1 K2_AUX
    s_setprio 0
    v_and_b32 v1, 63, v0
    v_lshlrev_b32 v10, 4, v1
    s_lshl_b32 s13, s8, 3
    s_lshl_b32 s14, s3, 1
    s_add_u32 s13, s13, s14
    s_lshl_b32 s14, s13, 12
    s_add_u32 s15, s14, 0x1000
    s_mov_b32 s28, 0x07060302
    s_waitcnt lgkmcnt(0)
    s_add_u32 s16, s4, 0x190000
    s_addc_u32 s17, s5, 0
    s_mov_b32 s18, 0x187000
    s_mov_b32 s19, 0x00020000
    buffer_load_dwordx4 v[80:83], v10, s[16:19], s14 offen offset:0
    buffer_load_dwordx4 v[84:87], v10, s[16:19], s14 offen offset:1024
    buffer_load_dwordx4 v[88:91], v10, s[16:19], s14 offen offset:2048
    buffer_load_dwordx4 v[92:95], v10, s[16:19], s14 offen offset:3072
    buffer_load_dwordx4 v[96:99], v10, s[16:19], s15 offen offset:0
    buffer_load_dwordx4 v[100:103], v10, s[16:19], s15 offen offset:1024
    buffer_load_dwordx4 v[104:107], v10, s[16:19], s15 offen offset:2048
    buffer_load_dwordx4 v[108:111], v10, s[16:19], s15 offen offset:3072
    s_getpc_b64 s[30:31]
K2_PC:
    s_sub_u32 s30, s30, K2_PC-attn_kernel
    s_subb_u32 s31, s31, 0
    v_lshlrev_b32 v11, 7, v0
    v_min_u32 v11, K2_END-attn_kernel, v11
    global_load_dword v224, v11, s[30:31]
    v_and_b32 v11, 31, v0
    v_lshrrev_b32 v12, 5, v1
    v_bfe_u32 v13, v11, 1, 1
    v_lshlrev_b32 v13, 2, v13
    v_bfe_u32 v14, v11, 2, 2
    v_or_b32 v13, v13, v14
    v_xor_b32 v13, v13, v12
    v_lshlrev_b32 v11, 7, v11
    v_xor_b32 v14, 0, v13
    v_lshl_add_u32 v2, v14, 4, v11
    v_xor_b32 v14, 2, v13
    v_lshl_add_u32 v3, v14, 4, v11
    v_xor_b32 v14, 4, v13
    v_lshl_add_u32 v4, v14, 4, v11
    v_xor_b32 v14, 6, v13
    v_lshl_add_u32 v5, v14, 4, v11
    v_bfe_u32 v11, v0, 2, 2
    v_lshl_add_u32 v13, v12, 2, v11
    v_lshlrev_b32 v13, 7, v13
    v_and_b32 v14, 1, v0
    v_lshl_add_u32 v13, v14, 3, v13
    v_bfe_u32 v14, v0, 4, 1
    v_lshlrev_b32 v14, 1, v14
    v_bfe_u32 v15, v0, 1, 1
    v_or_b32 v14, v14, v15
    v_lshrrev_b32 v11, 1, v11
    v_lshl_or_b32 v11, v11, 2, v12
    v_xor_b32 v14, v14, v11
    v_xor_b32 v15, 0, v14
    v_lshl_add_u32 v6, v15, 4, v13
    v_xor_b32 v15, 2, v14
    v_lshl_add_u32 v7, v15, 4, v13
    v_add_u32 v7, 1024, v7
    v_xor_b32 v15, 4, v14
    v_lshl_add_u32 v8, v15, 4, v13
    v_xor_b32 v15, 6, v14
    v_lshl_add_u32 v9, v15, 4, v13
    v_add_u32 v9, 1024, v9
    v_mov_b32 v16, 0
    v_mov_b32 v17, 0
    v_mov_b32 v18, 0
    v_mov_b32 v19, 0
    v_mov_b32 v20, 0
    v_mov_b32 v21, 0
    v_mov_b32 v22, 0
    v_mov_b32 v23, 0
    v_mov_b32 v24, 0
    v_mov_b32 v25, 0
    v_mov_b32 v26, 0
    v_mov_b32 v27, 0
    v_mov_b32 v28, 0
    v_mov_b32 v29, 0
    v_mov_b32 v30, 0
    v_mov_b32 v31, 0
    v_mov_b32 v32, 0
    v_mov_b32 v33, 0
    v_mov_b32 v34, 0
    v_mov_b32 v35, 0
    v_mov_b32 v36, 0
    v_mov_b32 v37, 0
    v_mov_b32 v38, 0
    v_mov_b32 v39, 0
    v_mov_b32 v40, 0
    v_mov_b32 v41, 0
    v_mov_b32 v42, 0
    v_mov_b32 v43, 0
    v_mov_b32 v44, 0
    v_mov_b32 v45, 0
    v_mov_b32 v46, 0
    v_mov_b32 v47, 0
    v_mov_b32 v48, 0
    v_mov_b32 v49, 0
    v_mov_b32 v50, 0
    v_mov_b32 v51, 0
    v_mov_b32 v52, 0
    v_mov_b32 v53, 0
    v_mov_b32 v54, 0
    v_mov_b32 v55, 0
    v_mov_b32 v56, 0
    v_mov_b32 v57, 0
    v_mov_b32 v58, 0
    v_mov_b32 v59, 0
    v_mov_b32 v60, 0
    v_mov_b32 v61, 0
    v_mov_b32 v62, 0
    v_mov_b32 v63, 0
    v_mov_b32 v64, 0
    v_mov_b32 v65, 0
    v_mov_b32 v66, 0
    v_mov_b32 v67, 0
    v_mov_b32 v68, 0
    v_mov_b32 v69, 0
    v_mov_b32 v70, 0
    v_mov_b32 v71, 0
    v_mov_b32 v72, 0
    v_mov_b32 v73, 0
    v_mov_b32 v74, 0
    v_mov_b32 v75, 0
    v_mov_b32 v76, 0
    v_mov_b32 v77, 0
    v_mov_b32 v78, 0
    v_mov_b32 v79, 0
    s_mul_i32 s20, s9, 392
    s_add_u32 s20, s20, s13
    s_lshl_b32 s20, s20, 12
    s_add_u32 s21, s20, 0x1000
    s_mul_i32 s22, s9, 50176
    s_lshl_b32 s23, s13, 7
    s_add_u32 s22, s22, s23
    v_and_b32 v11, 31, v0
    v_lshlrev_b32 v11, 2, v11
    s_add_u32 s24, s4, 0x650000
    s_addc_u32 s25, s5, 0
    s_mov_b32 s26, 0x3d400
    s_mov_b32 s27, 0x00020000
    s_cmp_eq_u32 s9, 4
    s_cselect_b32 s12, 10, 9
    s_barrier
    ds_read_b128 v[160:163], v2 offset:0
    ds_read_b128 v[164:167], v3 offset:0
    ds_read_b128 v[168:171], v4 offset:0
    ds_read_b128 v[172:175], v5 offset:0
    s_waitcnt vmcnt(1) lgkmcnt(0)
    s_add_u32 s16, s4, 0xac0000
    s_addc_u32 s17, s5, 0
    s_mov_b32 s18, 0x7a8000
    s_mov_b32 s19, 0x00020000
    v_mfma_f32_32x32x16_bf16 v[112:127], v[160:163], v[80:83], 0
    ds_read_b128 v[176:179], v2 offset:4096
    v_mfma_f32_32x32x16_bf16 v[112:127], v[164:167], v[84:87], v[112:127]
    ds_read_b128 v[180:183], v3 offset:4096
    v_mfma_f32_32x32x16_bf16 v[112:127], v[168:171], v[88:91], v[112:127]
    ds_read_b128 v[184:187], v4 offset:4096
    v_mfma_f32_32x32x16_bf16 v[112:127], v[172:175], v[92:95], v[112:127]
    ds_read_b128 v[188:191], v5 offset:4096
    v_mfma_f32_32x32x16_bf16 v[128:143], v[160:163], v[96:99], 0
    ds_read_b64_tr_b16 v[192:193], v6 offset:0
    ds_read_b64_tr_b16 v[194:195], v7 offset:0
    v_mfma_f32_32x32x16_bf16 v[128:143], v[164:167], v[100:103], v[128:143]
    ds_read_b64_tr_b16 v[196:197], v8 offset:0
    ds_read_b64_tr_b16 v[198:199], v9 offset:0
    v_mfma_f32_32x32x16_bf16 v[128:143], v[168:171], v[104:107], v[128:143]
    ds_read_b64_tr_b16 v[200:201], v6 offset:2048
    ds_read_b64_tr_b16 v[202:203], v7 offset:2048
    v_mfma_f32_32x32x16_bf16 v[128:143], v[172:175], v[108:111], v[128:143]
    ds_read_b64_tr_b16 v[204:205], v8 offset:2048
    ds_read_b64_tr_b16 v[206:207], v9 offset:2048
    v_exp_f32 v112, v112
    v_exp_f32 v113, v113
    v_exp_f32 v114, v114
    v_exp_f32 v115, v115
    v_perm_b32 v144, v113, v112, s28
    v_exp_f32 v116, v116
    v_exp_f32 v117, v117
    v_perm_b32 v145, v115, v114, s28
    v_exp_f32 v118, v118
    v_exp_f32 v119, v119
    v_perm_b32 v146, v117, v116, s28
    v_exp_f32 v120, v120
    v_exp_f32 v121, v121
    v_perm_b32 v147, v119, v118, s28
    v_exp_f32 v122, v122
    v_exp_f32 v123, v123
    v_perm_b32 v148, v121, v120, s28
    v_exp_f32 v124, v124
    v_exp_f32 v125, v125
    v_perm_b32 v149, v123, v122, s28
    v_exp_f32 v126, v126
    v_exp_f32 v127, v127
    v_perm_b32 v150, v125, v124, s28
    v_exp_f32 v128, v128
    v_exp_f32 v129, v129
    v_perm_b32 v151, v127, v126, s28
    s_waitcnt lgkmcnt(0)
    s_branch K2_R1
.p2align 6
K2_TOP:
    v_exp_f32 v128, v128
    v_exp_f32 v129, v129
    v_perm_b32 v151, v127, v126, s28
    v_mfma_f32_32x32x16_bf16 v[112:127], v[160:163], v[80:83], 0
    ds_read_b128 v[176:179], v2 offset:4096
    v_exp_f32 v130, v130
    v_exp_f32 v131, v131
    v_perm_b32 v152, v129, v128, s28
    v_mfma_f32_32x32x16_bf16 v[112:127], v[164:167], v[84:87], v[112:127]
    ds_read_b128 v[180:183], v3 offset:4096
    v_exp_f32 v132, v132
    v_exp_f32 v133, v133
    v_perm_b32 v153, v131, v130, s28
    v_mfma_f32_32x32x16_bf16 v[112:127], v[168:171], v[88:91], v[112:127]
    ds_read_b128 v[184:187], v4 offset:4096
    v_exp_f32 v134, v134
    v_exp_f32 v135, v135
    v_perm_b32 v154, v133, v132, s28
    v_mfma_f32_32x32x16_bf16 v[112:127], v[172:175], v[92:95], v[112:127]
    s_waitcnt lgkmcnt(3)
    v_exp_f32 v136, v136
    v_exp_f32 v137, v137
    v_perm_b32 v155, v135, v134, s28
    v_mfma_f32_32x32x16_bf16 v[16:31], v[208:211], v[144:147], v[16:31]
    ds_read_b128 v[188:191], v5 offset:4096
    v_exp_f32 v138, v138
    v_exp_f32 v139, v139
    v_perm_b32 v156, v137, v136, s28
    v_mfma_f32_32x32x16_bf16 v[32:47], v[212:215], v[144:147], v[32:47]
    ds_read_b64_tr_b16 v[192:193], v6 offset:0
    v_exp_f32 v140, v140
    v_exp_f32 v141, v141
    v_perm_b32 v157, v139, v138, s28
    v_mfma_f32_32x32x16_bf16 v[16:31], v[216:219], v[148:151], v[16:31]
    ds_read_b64_tr_b16 v[194:195], v7 offset:0
    v_exp_f32 v142, v142
    v_exp_f32 v143, v143
    v_perm_b32 v158, v141, v140, s28
    v_mfma_f32_32x32x16_bf16 v[32:47], v[220:223], v[148:151], v[32:47]
    ds_read_b64_tr_b16 v[196:197], v8 offset:0
    v_exp_f32 v112, v112
    v_exp_f32 v113, v113
    v_perm_b32 v159, v143, v142, s28
    v_mfma_f32_32x32x16_bf16 v[128:143], v[160:163], v[96:99], 0
    ds_read_b64_tr_b16 v[198:199], v9 offset:0
    v_exp_f32 v114, v114
    v_exp_f32 v115, v115
    v_perm_b32 v144, v113, v112, s28
    v_mfma_f32_32x32x16_bf16 v[128:143], v[164:167], v[100:103], v[128:143]
    ds_read_b64_tr_b16 v[200:201], v6 offset:2048
    v_exp_f32 v116, v116
    v_exp_f32 v117, v117
    v_perm_b32 v145, v115, v114, s28
    v_mfma_f32_32x32x16_bf16 v[128:143], v[168:171], v[104:107], v[128:143]
    ds_read_b64_tr_b16 v[202:203], v7 offset:2048
    v_exp_f32 v118, v118
    v_exp_f32 v119, v119
    v_perm_b32 v146, v117, v116, s28
    v_mfma_f32_32x32x16_bf16 v[128:143], v[172:175], v[108:111], v[128:143]
    ds_read_b64_tr_b16 v[204:205], v8 offset:2048
    v_exp_f32 v120, v120
    v_exp_f32 v121, v121
    v_perm_b32 v147, v119, v118, s28
    v_mfma_f32_32x32x16_bf16 v[48:63], v[208:211], v[152:155], v[48:63]
    ds_read_b64_tr_b16 v[206:207], v9 offset:2048
    v_exp_f32 v122, v122
    v_exp_f32 v123, v123
    v_perm_b32 v148, v121, v120, s28
    v_mfma_f32_32x32x16_bf16 v[64:79], v[212:215], v[152:155], v[64:79]
    v_exp_f32 v124, v124
    v_exp_f32 v125, v125
    v_perm_b32 v149, v123, v122, s28
    v_mfma_f32_32x32x16_bf16 v[48:63], v[216:219], v[156:159], v[48:63]
    s_waitcnt lgkmcnt(8)
    v_exp_f32 v126, v126
    v_exp_f32 v127, v127
    v_perm_b32 v150, v125, v124, s28
    v_mfma_f32_32x32x16_bf16 v[64:79], v[220:223], v[156:159], v[64:79]
    v_exp_f32 v128, v128
    v_exp_f32 v129, v129
    v_perm_b32 v151, v127, v126, s28
K2_R1:
    v_mfma_f32_32x32x16_bf16 v[112:127], v[176:179], v[80:83], 0
    ds_read_b128 v[160:163], v2 offset:8192
    v_exp_f32 v130, v130
    v_exp_f32 v131, v131
    v_perm_b32 v152, v129, v128, s28
    v_mfma_f32_32x32x16_bf16 v[112:127], v[180:183], v[84:87], v[112:127]
    ds_read_b128 v[164:167], v3 offset:8192
    v_exp_f32 v132, v132
    v_exp_f32 v133, v133
    v_perm_b32 v153, v131, v130, s28
    v_mfma_f32_32x32x16_bf16 v[112:127], v[184:187], v[88:91], v[112:127]
    ds_read_b128 v[168:171], v4 offset:8192
    v_exp_f32 v134, v134
    v_exp_f32 v135, v135
    v_perm_b32 v154, v133, v132, s28
    v_mfma_f32_32x32x16_bf16 v[112:127], v[188:191], v[92:95], v[112:127]
    s_waitcnt lgkmcnt(3)
    v_exp_f32 v136, v136
    v_exp_f32 v137, v137
    v_perm_b32 v155, v135, v134, s28
    v_mfma_f32_32x32x16_bf16 v[16:31], v[192:195], v[144:147], v[16:31]
    ds_read_b128 v[172:175], v5 offset:8192
    v_exp_f32 v138, v138
    v_exp_f32 v139, v139
    v_perm_b32 v156, v137, v136, s28
    v_mfma_f32_32x32x16_bf16 v[32:47], v[196:199], v[144:147], v[32:47]
    ds_read_b64_tr_b16 v[208:209], v6 offset:4096
    v_exp_f32 v140, v140
    v_exp_f32 v141, v141
    v_perm_b32 v157, v139, v138, s28
    v_mfma_f32_32x32x16_bf16 v[16:31], v[200:203], v[148:151], v[16:31]
    ds_read_b64_tr_b16 v[210:211], v7 offset:4096
    v_exp_f32 v142, v142
    v_exp_f32 v143, v143
    v_perm_b32 v158, v141, v140, s28
    v_mfma_f32_32x32x16_bf16 v[32:47], v[204:207], v[148:151], v[32:47]
    ds_read_b64_tr_b16 v[212:213], v8 offset:4096
    v_exp_f32 v112, v112
    v_exp_f32 v113, v113
    v_perm_b32 v159, v143, v142, s28
    v_mfma_f32_32x32x16_bf16 v[128:143], v[176:179], v[96:99], 0
    ds_read_b64_tr_b16 v[214:215], v9 offset:4096
    v_exp_f32 v114, v114
    v_exp_f32 v115, v115
    v_perm_b32 v144, v113, v112, s28
    v_mfma_f32_32x32x16_bf16 v[128:143], v[180:183], v[100:103], v[128:143]
    ds_read_b64_tr_b16 v[216:217], v6 offset:6144
    v_exp_f32 v116, v116
    v_exp_f32 v117, v117
    v_perm_b32 v145, v115, v114, s28
    v_mfma_f32_32x32x16_bf16 v[128:143], v[184:187], v[104:107], v[128:143]
    ds_read_b64_tr_b16 v[218:219], v7 offset:6144
    v_exp_f32 v118, v118
    v_exp_f32 v119, v119
    v_perm_b32 v146, v117, v116, s28
    v_mfma_f32_32x32x16_bf16 v[128:143], v[188:191], v[108:111], v[128:143]
    ds_read_b64_tr_b16 v[220:221], v8 offset:6144
    v_exp_f32 v120, v120
    v_exp_f32 v121, v121
    v_perm_b32 v147, v119, v118, s28
    v_mfma_f32_32x32x16_bf16 v[48:63], v[192:195], v[152:155], v[48:63]
    ds_read_b64_tr_b16 v[222:223], v9 offset:6144
    v_exp_f32 v122, v122
    v_exp_f32 v123, v123
    v_perm_b32 v148, v121, v120, s28
    v_mfma_f32_32x32x16_bf16 v[64:79], v[196:199], v[152:155], v[64:79]
    s_barrier
    v_exp_f32 v124, v124
    v_exp_f32 v125, v125
    v_perm_b32 v149, v123, v122, s28
    v_mfma_f32_32x32x16_bf16 v[48:63], v[200:203], v[156:159], v[48:63]
    s_waitcnt lgkmcnt(8)
    v_exp_f32 v126, v126
    v_exp_f32 v127, v127
    v_perm_b32 v150, v125, v124, s28
    v_mfma_f32_32x32x16_bf16 v[64:79], v[204:207], v[156:159], v[64:79]
    v_exp_f32 v128, v128
    v_exp_f32 v129, v129
    v_perm_b32 v151, v127, v126, s28
    v_mfma_f32_32x32x16_bf16 v[112:127], v[160:163], v[80:83], 0
    ds_read_b128 v[176:179], v2 offset:12288
    v_exp_f32 v130, v130
    v_exp_f32 v131, v131
    v_perm_b32 v152, v129, v128, s28
    v_mfma_f32_32x32x16_bf16 v[112:127], v[164:167], v[84:87], v[112:127]
    ds_read_b128 v[180:183], v3 offset:12288
    v_exp_f32 v132, v132
    v_exp_f32 v133, v133
    v_perm_b32 v153, v131, v130, s28
    v_mfma_f32_32x32x16_bf16 v[112:127], v[168:171], v[88:91], v[112:127]
    ds_read_b128 v[184:187], v4 offset:12288
    v_exp_f32 v134, v134
    v_exp_f32 v135, v135
    v_perm_b32 v154, v133, v132, s28
    v_mfma_f32_32x32x16_bf16 v[112:127], v[172:175], v[92:95], v[112:127]
    s_waitcnt lgkmcnt(3)
    v_exp_f32 v136, v136
    v_exp_f32 v137, v137
    v_perm_b32 v155, v135, v134, s28
    v_mfma_f32_32x32x16_bf16 v[16:31], v[208:211], v[144:147], v[16:31]
    ds_read_b128 v[188:191], v5 offset:12288
    v_exp_f32 v138, v138
    v_exp_f32 v139, v139
    v_perm_b32 v156, v137, v136, s28
    v_mfma_f32_32x32x16_bf16 v[32:47], v[212:215], v[144:147], v[32:47]
    ds_read_b64_tr_b16 v[192:193], v6 offset:8192
    v_exp_f32 v140, v140
    v_exp_f32 v141, v141
    v_perm_b32 v157, v139, v138, s28
    v_mfma_f32_32x32x16_bf16 v[16:31], v[216:219], v[148:151], v[16:31]
    ds_read_b64_tr_b16 v[194:195], v7 offset:8192
    v_exp_f32 v142, v142
    v_exp_f32 v143, v143
    v_perm_b32 v158, v141, v140, s28
    v_mfma_f32_32x32x16_bf16 v[32:47], v[220:223], v[148:151], v[32:47]
    ds_read_b64_tr_b16 v[196:197], v8 offset:8192
    v_exp_f32 v112, v112
    v_exp_f32 v113, v113
    v_perm_b32 v159, v143, v142, s28
    v_mfma_f32_32x32x16_bf16 v[128:143], v[160:163], v[96:99], 0
    ds_read_b64_tr_b16 v[198:199], v9 offset:8192
    v_exp_f32 v114, v114
    v_exp_f32 v115, v115
    v_perm_b32 v144, v113, v112, s28
    v_mfma_f32_32x32x16_bf16 v[128:143], v[164:167], v[100:103], v[128:143]
    ds_read_b64_tr_b16 v[200:201], v6 offset:10240
    v_exp_f32 v116, v116
    v_exp_f32 v117, v117
    v_perm_b32 v145, v115, v114, s28
    v_mfma_f32_32x32x16_bf16 v[128:143], v[168:171], v[104:107], v[128:143]
    ds_read_b64_tr_b16 v[202:203], v7 offset:10240
    v_exp_f32 v118, v118
    v_exp_f32 v119, v119
    v_perm_b32 v146, v117, v116, s28
    v_mfma_f32_32x32x16_bf16 v[128:143], v[172:175], v[108:111], v[128:143]
    ds_read_b64_tr_b16 v[204:205], v8 offset:10240
    v_exp_f32 v120, v120
    v_exp_f32 v121, v121
    v_perm_b32 v147, v119, v118, s28
    v_mfma_f32_32x32x16_bf16 v[48:63], v[208:211], v[152:155], v[48:63]
    ds_read_b64_tr_b16 v[206:207], v9 offset:10240
    v_exp_f32 v122, v122
    v_exp_f32 v123, v123
    v_perm_b32 v148, v121, v120, s28
    v_mfma_f32_32x32x16_bf16 v[64:79], v[212:215], v[152:155], v[64:79]
    v_exp_f32 v124, v124
    v_exp_f32 v125, v125
    v_perm_b32 v149, v123, v122, s28
    v_mfma_f32_32x32x16_bf16 v[48:63], v[216:219], v[156:159], v[48:63]
    s_sub_u32 s12, s12, 1
    s_waitcnt lgkmcnt(8)
    v_exp_f32 v126, v126
    v_exp_f32 v127, v127
    v_perm_b32 v150, v125, v124, s28
    v_mfma_f32_32x32x16_bf16 v[64:79], v[220:223], v[156:159], v[64:79]
    s_cbranch_scc1 K2_E0
    v_exp_f32 v128, v128
    v_exp_f32 v129, v129
    v_perm_b32 v151, v127, v126, s28
    v_mfma_f32_32x32x16_bf16 v[112:127], v[176:179], v[80:83], 0
    ds_read_b128 v[160:163], v2 offset:16384
    v_exp_f32 v130, v130
    v_exp_f32 v131, v131
    v_perm_b32 v152, v129, v128, s28
    v_mfma_f32_32x32x16_bf16 v[112:127], v[180:183], v[84:87], v[112:127]
    ds_read_b128 v[164:167], v3 offset:16384
    v_exp_f32 v132, v132
    v_exp_f32 v133, v133
    v_perm_b32 v153, v131, v130, s28
    v_mfma_f32_32x32x16_bf16 v[112:127], v[184:187], v[88:91], v[112:127]
    ds_read_b128 v[168:171], v4 offset:16384
    v_exp_f32 v134, v134
    v_exp_f32 v135, v135
    v_perm_b32 v154, v133, v132, s28
    v_mfma_f32_32x32x16_bf16 v[112:127], v[188:191], v[92:95], v[112:127]
    s_waitcnt lgkmcnt(3)
    v_exp_f32 v136, v136
    v_exp_f32 v137, v137
    v_perm_b32 v155, v135, v134, s28
    v_mfma_f32_32x32x16_bf16 v[16:31], v[192:195], v[144:147], v[16:31]
    ds_read_b128 v[172:175], v5 offset:16384
    v_exp_f32 v138, v138
    v_exp_f32 v139, v139
    v_perm_b32 v156, v137, v136, s28
    v_mfma_f32_32x32x16_bf16 v[32:47], v[196:199], v[144:147], v[32:47]
    ds_read_b64_tr_b16 v[208:209], v6 offset:12288
    v_exp_f32 v140, v140
    v_exp_f32 v141, v141
    v_perm_b32 v157, v139, v138, s28
    v_mfma_f32_32x32x16_bf16 v[16:31], v[200:203], v[148:151], v[16:31]
    ds_read_b64_tr_b16 v[210:211], v7 offset:12288
    v_exp_f32 v142, v142
    v_exp_f32 v143, v143
    v_perm_b32 v158, v141, v140, s28
    v_mfma_f32_32x32x16_bf16 v[32:47], v[204:207], v[148:151], v[32:47]
    ds_read_b64_tr_b16 v[212:213], v8 offset:12288
    v_exp_f32 v112, v112
    v_exp_f32 v113, v113
    v_perm_b32 v159, v143, v142, s28
    v_mfma_f32_32x32x16_bf16 v[128:143], v[176:179], v[96:99], 0
    ds_read_b64_tr_b16 v[214:215], v9 offset:12288
    v_exp_f32 v114, v114
    v_exp_f32 v115, v115
    v_perm_b32 v144, v113, v112, s28
    v_mfma_f32_32x32x16_bf16 v[128:143], v[180:183], v[100:103], v[128:143]
    ds_read_b64_tr_b16 v[216:217], v6 offset:14336
    v_exp_f32 v116, v116
    v_exp_f32 v117, v117
    v_perm_b32 v145, v115, v114, s28
    v_mfma_f32_32x32x16_bf16 v[128:143], v[184:187], v[104:107], v[128:143]
    ds_read_b64_tr_b16 v[218:219], v7 offset:14336
    v_exp_f32 v118, v118
    v_exp_f32 v119, v119
    v_perm_b32 v146, v117, v116, s28
    v_mfma_f32_32x32x16_bf16 v[128:143], v[188:191], v[108:111], v[128:143]
    ds_read_b64_tr_b16 v[220:221], v8 offset:14336
    v_exp_f32 v120, v120
    v_exp_f32 v121, v121
    v_perm_b32 v147, v119, v118, s28
    v_mfma_f32_32x32x16_bf16 v[48:63], v[192:195], v[152:155], v[48:63]
    ds_read_b64_tr_b16 v[222:223], v9 offset:14336
    v_exp_f32 v122, v122
    v_exp_f32 v123, v123
    v_perm_b32 v148, v121, v120, s28
    v_mfma_f32_32x32x16_bf16 v[64:79], v[196:199], v[152:155], v[64:79]
    s_barrier
    v_exp_f32 v124, v124
    v_exp_f32 v125, v125
    v_perm_b32 v149, v123, v122, s28
    v_mfma_f32_32x32x16_bf16 v[48:63], v[200:203], v[156:159], v[48:63]
    s_waitcnt lgkmcnt(8)
    v_exp_f32 v126, v126
    v_exp_f32 v127, v127
    v_perm_b32 v150, v125, v124, s28
    v_mfma_f32_32x32x16_bf16 v[64:79], v[204:207], v[156:159], v[64:79]
    v_exp_f32 v128, v128
    v_exp_f32 v129, v129
    v_perm_b32 v151, v127, v126, s28
    v_mfma_f32_32x32x16_bf16 v[112:127], v[160:163], v[80:83], 0
    ds_read_b128 v[176:179], v2 offset:20480
    v_exp_f32 v130, v130
    v_exp_f32 v131, v131
    v_perm_b32 v152, v129, v128, s28
    v_mfma_f32_32x32x16_bf16 v[112:127], v[164:167], v[84:87], v[112:127]
    ds_read_b128 v[180:183], v3 offset:20480
    v_exp_f32 v132, v132
    v_exp_f32 v133, v133
    v_perm_b32 v153, v131, v130, s28
    v_mfma_f32_32x32x16_bf16 v[112:127], v[168:171], v[88:91], v[112:127]
    ds_read_b128 v[184:187], v4 offset:20480
    v_exp_f32 v134, v134
    v_exp_f32 v135, v135
    v_perm_b32 v154, v133, v132, s28
    v_mfma_f32_32x32x16_bf16 v[112:127], v[172:175], v[92:95], v[112:127]
    s_waitcnt lgkmcnt(3)
    v_exp_f32 v136, v136
    v_exp_f32 v137, v137
    v_perm_b32 v155, v135, v134, s28
    v_mfma_f32_32x32x16_bf16 v[16:31], v[208:211], v[144:147], v[16:31]
    ds_read_b128 v[188:191], v5 offset:20480
    v_exp_f32 v138, v138
    v_exp_f32 v139, v139
    v_perm_b32 v156, v137, v136, s28
    v_mfma_f32_32x32x16_bf16 v[32:47], v[212:215], v[144:147], v[32:47]
    ds_read_b64_tr_b16 v[192:193], v6 offset:16384
    v_exp_f32 v140, v140
    v_exp_f32 v141, v141
    v_perm_b32 v157, v139, v138, s28
    v_mfma_f32_32x32x16_bf16 v[16:31], v[216:219], v[148:151], v[16:31]
    ds_read_b64_tr_b16 v[194:195], v7 offset:16384
    v_exp_f32 v142, v142
    v_exp_f32 v143, v143
    v_perm_b32 v158, v141, v140, s28
    v_mfma_f32_32x32x16_bf16 v[32:47], v[220:223], v[148:151], v[32:47]
    ds_read_b64_tr_b16 v[196:197], v8 offset:16384
    v_exp_f32 v112, v112
    v_exp_f32 v113, v113
    v_perm_b32 v159, v143, v142, s28
    v_mfma_f32_32x32x16_bf16 v[128:143], v[160:163], v[96:99], 0
    ds_read_b64_tr_b16 v[198:199], v9 offset:16384
    v_exp_f32 v114, v114
    v_exp_f32 v115, v115
    v_perm_b32 v144, v113, v112, s28
    v_mfma_f32_32x32x16_bf16 v[128:143], v[164:167], v[100:103], v[128:143]
    ds_read_b64_tr_b16 v[200:201], v6 offset:18432
    v_exp_f32 v116, v116
    v_exp_f32 v117, v117
    v_perm_b32 v145, v115, v114, s28
    v_mfma_f32_32x32x16_bf16 v[128:143], v[168:171], v[104:107], v[128:143]
    ds_read_b64_tr_b16 v[202:203], v7 offset:18432
    v_exp_f32 v118, v118
    v_exp_f32 v119, v119
    v_perm_b32 v146, v117, v116, s28
    v_mfma_f32_32x32x16_bf16 v[128:143], v[172:175], v[108:111], v[128:143]
    ds_read_b64_tr_b16 v[204:205], v8 offset:18432
    v_exp_f32 v120, v120
    v_exp_f32 v121, v121
    v_perm_b32 v147, v119, v118, s28
    v_mfma_f32_32x32x16_bf16 v[48:63], v[208:211], v[152:155], v[48:63]
    ds_read_b64_tr_b16 v[206:207], v9 offset:18432
    v_exp_f32 v122, v122
    v_exp_f32 v123, v123
    v_perm_b32 v148, v121, v120, s28
    v_mfma_f32_32x32x16_bf16 v[64:79], v[212:215], v[152:155], v[64:79]
    v_exp_f32 v124, v124
    v_exp_f32 v125, v125
    v_perm_b32 v149, v123, v122, s28
    v_mfma_f32_32x32x16_bf16 v[48:63], v[216:219], v[156:159], v[48:63]
    s_waitcnt lgkmcnt(8)
    v_exp_f32 v126, v126
    v_exp_f32 v127, v127
    v_perm_b32 v150, v125, v124, s28
    v_mfma_f32_32x32x16_bf16 v[64:79], v[220:223], v[156:159], v[64:79]
    v_exp_f32 v128, v128
    v_exp_f32 v129, v129
    v_perm_b32 v151, v127, v126, s28
    v_mfma_f32_32x32x16_bf16 v[112:127], v[176:179], v[80:83], 0
    ds_read_b128 v[160:163], v2 offset:24576
    v_exp_f32 v130, v130
    v_exp_f32 v131, v131
    v_perm_b32 v152, v129, v128, s28
    v_mfma_f32_32x32x16_bf16 v[112:127], v[180:183], v[84:87], v[112:127]
    ds_read_b128 v[164:167], v3 offset:24576
    v_exp_f32 v132, v132
    v_exp_f32 v133, v133
    v_perm_b32 v153, v131, v130, s28
    v_mfma_f32_32x32x16_bf16 v[112:127], v[184:187], v[88:91], v[112:127]
    ds_read_b128 v[168:171], v4 offset:24576
    v_exp_f32 v134, v134
    v_exp_f32 v135, v135
    v_perm_b32 v154, v133, v132, s28
    v_mfma_f32_32x32x16_bf16 v[112:127], v[188:191], v[92:95], v[112:127]
    s_waitcnt lgkmcnt(3)
    v_exp_f32 v136, v136
    v_exp_f32 v137, v137
    v_perm_b32 v155, v135, v134, s28
    v_mfma_f32_32x32x16_bf16 v[16:31], v[192:195], v[144:147], v[16:31]
    ds_read_b128 v[172:175], v5 offset:24576
    v_exp_f32 v138, v138
    v_exp_f32 v139, v139
    v_perm_b32 v156, v137, v136, s28
    v_mfma_f32_32x32x16_bf16 v[32:47], v[196:199], v[144:147], v[32:47]
    ds_read_b64_tr_b16 v[208:209], v6 offset:20480
    v_exp_f32 v140, v140
    v_exp_f32 v141, v141
    v_perm_b32 v157, v139, v138, s28
    v_mfma_f32_32x32x16_bf16 v[16:31], v[200:203], v[148:151], v[16:31]
    ds_read_b64_tr_b16 v[210:211], v7 offset:20480
    v_exp_f32 v142, v142
    v_exp_f32 v143, v143
    v_perm_b32 v158, v141, v140, s28
    v_mfma_f32_32x32x16_bf16 v[32:47], v[204:207], v[148:151], v[32:47]
    ds_read_b64_tr_b16 v[212:213], v8 offset:20480
    v_exp_f32 v112, v112
    v_exp_f32 v113, v113
    v_perm_b32 v159, v143, v142, s28
    v_mfma_f32_32x32x16_bf16 v[128:143], v[176:179], v[96:99], 0
    ds_read_b64_tr_b16 v[214:215], v9 offset:20480
    v_exp_f32 v114, v114
    v_exp_f32 v115, v115
    v_perm_b32 v144, v113, v112, s28
    v_mfma_f32_32x32x16_bf16 v[128:143], v[180:183], v[100:103], v[128:143]
    ds_read_b64_tr_b16 v[216:217], v6 offset:22528
    v_exp_f32 v116, v116
    v_exp_f32 v117, v117
    v_perm_b32 v145, v115, v114, s28
    v_mfma_f32_32x32x16_bf16 v[128:143], v[184:187], v[104:107], v[128:143]
    ds_read_b64_tr_b16 v[218:219], v7 offset:22528
    v_exp_f32 v118, v118
    v_exp_f32 v119, v119
    v_perm_b32 v146, v117, v116, s28
    v_mfma_f32_32x32x16_bf16 v[128:143], v[188:191], v[108:111], v[128:143]
    ds_read_b64_tr_b16 v[220:221], v8 offset:22528
    v_exp_f32 v120, v120
    v_exp_f32 v121, v121
    v_perm_b32 v147, v119, v118, s28
    v_mfma_f32_32x32x16_bf16 v[48:63], v[192:195], v[152:155], v[48:63]
    ds_read_b64_tr_b16 v[222:223], v9 offset:22528
    v_exp_f32 v122, v122
    v_exp_f32 v123, v123
    v_perm_b32 v148, v121, v120, s28
    v_mfma_f32_32x32x16_bf16 v[64:79], v[196:199], v[152:155], v[64:79]
    s_barrier
    v_exp_f32 v124, v124
    v_exp_f32 v125, v125
    v_perm_b32 v149, v123, v122, s28
    v_mfma_f32_32x32x16_bf16 v[48:63], v[200:203], v[156:159], v[48:63]
    s_waitcnt lgkmcnt(8)
    v_exp_f32 v126, v126
    v_exp_f32 v127, v127
    v_perm_b32 v150, v125, v124, s28
    v_mfma_f32_32x32x16_bf16 v[64:79], v[204:207], v[156:159], v[64:79]
    v_exp_f32 v128, v128
    v_exp_f32 v129, v129
    v_perm_b32 v151, v127, v126, s28
    v_mfma_f32_32x32x16_bf16 v[112:127], v[160:163], v[80:83], 0
    ds_read_b128 v[176:179], v2 offset:28672
    v_exp_f32 v130, v130
    v_exp_f32 v131, v131
    v_perm_b32 v152, v129, v128, s28
    v_mfma_f32_32x32x16_bf16 v[112:127], v[164:167], v[84:87], v[112:127]
    ds_read_b128 v[180:183], v3 offset:28672
    v_exp_f32 v132, v132
    v_exp_f32 v133, v133
    v_perm_b32 v153, v131, v130, s28
    v_mfma_f32_32x32x16_bf16 v[112:127], v[168:171], v[88:91], v[112:127]
    ds_read_b128 v[184:187], v4 offset:28672
    v_exp_f32 v134, v134
    v_exp_f32 v135, v135
    v_perm_b32 v154, v133, v132, s28
    v_mfma_f32_32x32x16_bf16 v[112:127], v[172:175], v[92:95], v[112:127]
    s_waitcnt lgkmcnt(3)
    v_exp_f32 v136, v136
    v_exp_f32 v137, v137
    v_perm_b32 v155, v135, v134, s28
    v_mfma_f32_32x32x16_bf16 v[16:31], v[208:211], v[144:147], v[16:31]
    ds_read_b128 v[188:191], v5 offset:28672
    v_exp_f32 v138, v138
    v_exp_f32 v139, v139
    v_perm_b32 v156, v137, v136, s28
    v_mfma_f32_32x32x16_bf16 v[32:47], v[212:215], v[144:147], v[32:47]
    ds_read_b64_tr_b16 v[192:193], v6 offset:24576
    v_exp_f32 v140, v140
    v_exp_f32 v141, v141
    v_perm_b32 v157, v139, v138, s28
    v_mfma_f32_32x32x16_bf16 v[16:31], v[216:219], v[148:151], v[16:31]
    ds_read_b64_tr_b16 v[194:195], v7 offset:24576
    v_exp_f32 v142, v142
    v_exp_f32 v143, v143
    v_perm_b32 v158, v141, v140, s28
    v_mfma_f32_32x32x16_bf16 v[32:47], v[220:223], v[148:151], v[32:47]
    ds_read_b64_tr_b16 v[196:197], v8 offset:24576
    v_exp_f32 v112, v112
    v_exp_f32 v113, v113
    v_perm_b32 v159, v143, v142, s28
    v_mfma_f32_32x32x16_bf16 v[128:143], v[160:163], v[96:99], 0
    ds_read_b64_tr_b16 v[198:199], v9 offset:24576
    v_exp_f32 v114, v114
    v_exp_f32 v115, v115
    v_perm_b32 v144, v113, v112, s28
    v_mfma_f32_32x32x16_bf16 v[128:143], v[164:167], v[100:103], v[128:143]
    ds_read_b64_tr_b16 v[200:201], v6 offset:26624
    v_exp_f32 v116, v116
    v_exp_f32 v117, v117
    v_perm_b32 v145, v115, v114, s28
    v_mfma_f32_32x32x16_bf16 v[128:143], v[168:171], v[104:107], v[128:143]
    ds_read_b64_tr_b16 v[202:203], v7 offset:26624
    v_exp_f32 v118, v118
    v_exp_f32 v119, v119
    v_perm_b32 v146, v117, v116, s28
    v_mfma_f32_32x32x16_bf16 v[128:143], v[172:175], v[108:111], v[128:143]
    ds_read_b64_tr_b16 v[204:205], v8 offset:26624
    v_exp_f32 v120, v120
    v_exp_f32 v121, v121
    v_perm_b32 v147, v119, v118, s28
    v_mfma_f32_32x32x16_bf16 v[48:63], v[208:211], v[152:155], v[48:63]
    ds_read_b64_tr_b16 v[206:207], v9 offset:26624
    v_exp_f32 v122, v122
    v_exp_f32 v123, v123
    v_perm_b32 v148, v121, v120, s28
    v_mfma_f32_32x32x16_bf16 v[64:79], v[212:215], v[152:155], v[64:79]
    v_exp_f32 v124, v124
    v_exp_f32 v125, v125
    v_perm_b32 v149, v123, v122, s28
    v_mfma_f32_32x32x16_bf16 v[48:63], v[216:219], v[156:159], v[48:63]
    s_waitcnt lgkmcnt(8)
    v_exp_f32 v126, v126
    v_exp_f32 v127, v127
    v_perm_b32 v150, v125, v124, s28
    v_mfma_f32_32x32x16_bf16 v[64:79], v[220:223], v[156:159], v[64:79]
    v_exp_f32 v128, v128
    v_exp_f32 v129, v129
    v_perm_b32 v151, v127, v126, s28
    v_mfma_f32_32x32x16_bf16 v[112:127], v[176:179], v[80:83], 0
    ds_read_b128 v[160:163], v2 offset:32768
    v_exp_f32 v130, v130
    v_exp_f32 v131, v131
    v_perm_b32 v152, v129, v128, s28
    v_mfma_f32_32x32x16_bf16 v[112:127], v[180:183], v[84:87], v[112:127]
    ds_read_b128 v[164:167], v3 offset:32768
    v_exp_f32 v132, v132
    v_exp_f32 v133, v133
    v_perm_b32 v153, v131, v130, s28
    v_mfma_f32_32x32x16_bf16 v[112:127], v[184:187], v[88:91], v[112:127]
    ds_read_b128 v[168:171], v4 offset:32768
    v_exp_f32 v134, v134
    v_exp_f32 v135, v135
    v_perm_b32 v154, v133, v132, s28
    v_mfma_f32_32x32x16_bf16 v[112:127], v[188:191], v[92:95], v[112:127]
    s_waitcnt lgkmcnt(3)
    v_exp_f32 v136, v136
    v_exp_f32 v137, v137
    v_perm_b32 v155, v135, v134, s28
    v_mfma_f32_32x32x16_bf16 v[16:31], v[192:195], v[144:147], v[16:31]
    ds_read_b128 v[172:175], v5 offset:32768
    v_exp_f32 v138, v138
    v_exp_f32 v139, v139
    v_perm_b32 v156, v137, v136, s28
    v_mfma_f32_32x32x16_bf16 v[32:47], v[196:199], v[144:147], v[32:47]
    ds_read_b64_tr_b16 v[208:209], v6 offset:28672
    v_exp_f32 v140, v140
    v_exp_f32 v141, v141
    v_perm_b32 v157, v139, v138, s28
    v_mfma_f32_32x32x16_bf16 v[16:31], v[200:203], v[148:151], v[16:31]
    ds_read_b64_tr_b16 v[210:211], v7 offset:28672
    v_exp_f32 v142, v142
    v_exp_f32 v143, v143
    v_perm_b32 v158, v141, v140, s28
    v_mfma_f32_32x32x16_bf16 v[32:47], v[204:207], v[148:151], v[32:47]
    ds_read_b64_tr_b16 v[212:213], v8 offset:28672
    v_exp_f32 v112, v112
    v_exp_f32 v113, v113
    v_perm_b32 v159, v143, v142, s28
    v_mfma_f32_32x32x16_bf16 v[128:143], v[176:179], v[96:99], 0
    ds_read_b64_tr_b16 v[214:215], v9 offset:28672
    v_exp_f32 v114, v114
    v_exp_f32 v115, v115
    v_perm_b32 v144, v113, v112, s28
    v_mfma_f32_32x32x16_bf16 v[128:143], v[180:183], v[100:103], v[128:143]
    ds_read_b64_tr_b16 v[216:217], v6 offset:30720
    v_exp_f32 v116, v116
    v_exp_f32 v117, v117
    v_perm_b32 v145, v115, v114, s28
    v_mfma_f32_32x32x16_bf16 v[128:143], v[184:187], v[104:107], v[128:143]
    ds_read_b64_tr_b16 v[218:219], v7 offset:30720
    v_exp_f32 v118, v118
    v_exp_f32 v119, v119
    v_perm_b32 v146, v117, v116, s28
    v_mfma_f32_32x32x16_bf16 v[128:143], v[188:191], v[108:111], v[128:143]
    ds_read_b64_tr_b16 v[220:221], v8 offset:30720
    v_exp_f32 v120, v120
    v_exp_f32 v121, v121
    v_perm_b32 v147, v119, v118, s28
    v_mfma_f32_32x32x16_bf16 v[48:63], v[192:195], v[152:155], v[48:63]
    ds_read_b64_tr_b16 v[222:223], v9 offset:30720
    v_exp_f32 v122, v122
    v_exp_f32 v123, v123
    v_perm_b32 v148, v121, v120, s28
    v_mfma_f32_32x32x16_bf16 v[64:79], v[196:199], v[152:155], v[64:79]
    s_barrier
    v_exp_f32 v124, v124
    v_exp_f32 v125, v125
    v_perm_b32 v149, v123, v122, s28
    v_mfma_f32_32x32x16_bf16 v[48:63], v[200:203], v[156:159], v[48:63]
    s_waitcnt lgkmcnt(8)
    v_exp_f32 v126, v126
    v_exp_f32 v127, v127
    v_perm_b32 v150, v125, v124, s28
    v_mfma_f32_32x32x16_bf16 v[64:79], v[204:207], v[156:159], v[64:79]
    v_exp_f32 v128, v128
    v_exp_f32 v129, v129
    v_perm_b32 v151, v127, v126, s28
    v_mfma_f32_32x32x16_bf16 v[112:127], v[160:163], v[80:83], 0
    ds_read_b128 v[176:179], v2 offset:36864
    v_exp_f32 v130, v130
    v_exp_f32 v131, v131
    v_perm_b32 v152, v129, v128, s28
    v_mfma_f32_32x32x16_bf16 v[112:127], v[164:167], v[84:87], v[112:127]
    ds_read_b128 v[180:183], v3 offset:36864
    v_exp_f32 v132, v132
    v_exp_f32 v133, v133
    v_perm_b32 v153, v131, v130, s28
    v_mfma_f32_32x32x16_bf16 v[112:127], v[168:171], v[88:91], v[112:127]
    ds_read_b128 v[184:187], v4 offset:36864
    v_exp_f32 v134, v134
    v_exp_f32 v135, v135
    v_perm_b32 v154, v133, v132, s28
    v_mfma_f32_32x32x16_bf16 v[112:127], v[172:175], v[92:95], v[112:127]
    s_waitcnt lgkmcnt(3)
    v_exp_f32 v136, v136
    v_exp_f32 v137, v137
    v_perm_b32 v155, v135, v134, s28
    v_mfma_f32_32x32x16_bf16 v[16:31], v[208:211], v[144:147], v[16:31]
    ds_read_b128 v[188:191], v5 offset:36864
    v_exp_f32 v138, v138
    v_exp_f32 v139, v139
    v_perm_b32 v156, v137, v136, s28
    v_mfma_f32_32x32x16_bf16 v[32:47], v[212:215], v[144:147], v[32:47]
    ds_read_b64_tr_b16 v[192:193], v6 offset:32768
    v_exp_f32 v140, v140
    v_exp_f32 v141, v141
    v_perm_b32 v157, v139, v138, s28
    v_mfma_f32_32x32x16_bf16 v[16:31], v[216:219], v[148:151], v[16:31]
    ds_read_b64_tr_b16 v[194:195], v7 offset:32768
    v_exp_f32 v142, v142
    v_exp_f32 v143, v143
    v_perm_b32 v158, v141, v140, s28
    v_mfma_f32_32x32x16_bf16 v[32:47], v[220:223], v[148:151], v[32:47]
    ds_read_b64_tr_b16 v[196:197], v8 offset:32768
    v_exp_f32 v112, v112
    v_exp_f32 v113, v113
    v_perm_b32 v159, v143, v142, s28
    v_mfma_f32_32x32x16_bf16 v[128:143], v[160:163], v[96:99], 0
    ds_read_b64_tr_b16 v[198:199], v9 offset:32768
    v_exp_f32 v114, v114
    v_exp_f32 v115, v115
    v_perm_b32 v144, v113, v112, s28
    v_mfma_f32_32x32x16_bf16 v[128:143], v[164:167], v[100:103], v[128:143]
    ds_read_b64_tr_b16 v[200:201], v6 offset:34816
    v_exp_f32 v116, v116
    v_exp_f32 v117, v117
    v_perm_b32 v145, v115, v114, s28
    v_mfma_f32_32x32x16_bf16 v[128:143], v[168:171], v[104:107], v[128:143]
    ds_read_b64_tr_b16 v[202:203], v7 offset:34816
    v_exp_f32 v118, v118
    v_exp_f32 v119, v119
    v_perm_b32 v146, v117, v116, s28
    v_mfma_f32_32x32x16_bf16 v[128:143], v[172:175], v[108:111], v[128:143]
    ds_read_b64_tr_b16 v[204:205], v8 offset:34816
    v_exp_f32 v120, v120
    v_exp_f32 v121, v121
    v_perm_b32 v147, v119, v118, s28
    v_mfma_f32_32x32x16_bf16 v[48:63], v[208:211], v[152:155], v[48:63]
    ds_read_b64_tr_b16 v[206:207], v9 offset:34816
    v_exp_f32 v122, v122
    v_exp_f32 v123, v123
    v_perm_b32 v148, v121, v120, s28
    v_mfma_f32_32x32x16_bf16 v[64:79], v[212:215], v[152:155], v[64:79]
    v_exp_f32 v124, v124
    v_exp_f32 v125, v125
    v_perm_b32 v149, v123, v122, s28
    v_mfma_f32_32x32x16_bf16 v[48:63], v[216:219], v[156:159], v[48:63]
    s_waitcnt lgkmcnt(8)
    v_exp_f32 v126, v126
    v_exp_f32 v127, v127
    v_perm_b32 v150, v125, v124, s28
    v_mfma_f32_32x32x16_bf16 v[64:79], v[220:223], v[156:159], v[64:79]
    v_exp_f32 v128, v128
    v_exp_f32 v129, v129
    v_perm_b32 v151, v127, v126, s28
    v_mfma_f32_32x32x16_bf16 v[112:127], v[176:179], v[80:83], 0
    ds_read_b128 v[160:163], v2 offset:40960
    v_exp_f32 v130, v130
    v_exp_f32 v131, v131
    v_perm_b32 v152, v129, v128, s28
    v_mfma_f32_32x32x16_bf16 v[112:127], v[180:183], v[84:87], v[112:127]
    ds_read_b128 v[164:167], v3 offset:40960
    v_exp_f32 v132, v132
    v_exp_f32 v133, v133
    v_perm_b32 v153, v131, v130, s28
    v_mfma_f32_32x32x16_bf16 v[112:127], v[184:187], v[88:91], v[112:127]
    ds_read_b128 v[168:171], v4 offset:40960
    v_exp_f32 v134, v134
    v_exp_f32 v135, v135
    v_perm_b32 v154, v133, v132, s28
    v_mfma_f32_32x32x16_bf16 v[112:127], v[188:191], v[92:95], v[112:127]
    s_waitcnt lgkmcnt(3)
    v_exp_f32 v136, v136
    v_exp_f32 v137, v137
    v_perm_b32 v155, v135, v134, s28
    v_mfma_f32_32x32x16_bf16 v[16:31], v[192:195], v[144:147], v[16:31]
    ds_read_b128 v[172:175], v5 offset:40960
    v_exp_f32 v138, v138
    v_exp_f32 v139, v139
    v_perm_b32 v156, v137, v136, s28
    v_mfma_f32_32x32x16_bf16 v[32:47], v[196:199], v[144:147], v[32:47]
    ds_read_b64_tr_b16 v[208:209], v6 offset:36864
    v_exp_f32 v140, v140
    v_exp_f32 v141, v141
    v_perm_b32 v157, v139, v138, s28
    v_mfma_f32_32x32x16_bf16 v[16:31], v[200:203], v[148:151], v[16:31]
    ds_read_b64_tr_b16 v[210:211], v7 offset:36864
    v_exp_f32 v142, v142
    v_exp_f32 v143, v143
    v_perm_b32 v158, v141, v140, s28
    v_mfma_f32_32x32x16_bf16 v[32:47], v[204:207], v[148:151], v[32:47]
    ds_read_b64_tr_b16 v[212:213], v8 offset:36864
    v_exp_f32 v112, v112
    v_exp_f32 v113, v113
    v_perm_b32 v159, v143, v142, s28
    v_mfma_f32_32x32x16_bf16 v[128:143], v[176:179], v[96:99], 0
    ds_read_b64_tr_b16 v[214:215], v9 offset:36864
    v_exp_f32 v114, v114
    v_exp_f32 v115, v115
    v_perm_b32 v144, v113, v112, s28
    v_mfma_f32_32x32x16_bf16 v[128:143], v[180:183], v[100:103], v[128:143]
    ds_read_b64_tr_b16 v[216:217], v6 offset:38912
    v_exp_f32 v116, v116
    v_exp_f32 v117, v117
    v_perm_b32 v145, v115, v114, s28
    v_mfma_f32_32x32x16_bf16 v[128:143], v[184:187], v[104:107], v[128:143]
    ds_read_b64_tr_b16 v[218:219], v7 offset:38912
    v_exp_f32 v118, v118
    v_exp_f32 v119, v119
    v_perm_b32 v146, v117, v116, s28
    v_mfma_f32_32x32x16_bf16 v[128:143], v[188:191], v[108:111], v[128:143]
    ds_read_b64_tr_b16 v[220:221], v8 offset:38912
    v_exp_f32 v120, v120
    v_exp_f32 v121, v121
    v_perm_b32 v147, v119, v118, s28
    v_mfma_f32_32x32x16_bf16 v[48:63], v[192:195], v[152:155], v[48:63]
    ds_read_b64_tr_b16 v[222:223], v9 offset:38912
    v_exp_f32 v122, v122
    v_exp_f32 v123, v123
    v_perm_b32 v148, v121, v120, s28
    v_mfma_f32_32x32x16_bf16 v[64:79], v[196:199], v[152:155], v[64:79]
    s_barrier
    v_exp_f32 v124, v124
    v_exp_f32 v125, v125
    v_perm_b32 v149, v123, v122, s28
    v_mfma_f32_32x32x16_bf16 v[48:63], v[200:203], v[156:159], v[48:63]
    s_waitcnt lgkmcnt(8)
    v_exp_f32 v126, v126
    v_exp_f32 v127, v127
    v_perm_b32 v150, v125, v124, s28
    v_mfma_f32_32x32x16_bf16 v[64:79], v[204:207], v[156:159], v[64:79]
    v_exp_f32 v128, v128
    v_exp_f32 v129, v129
    v_perm_b32 v151, v127, v126, s28
    v_mfma_f32_32x32x16_bf16 v[112:127], v[160:163], v[80:83], 0
    ds_read_b128 v[176:179], v2 offset:45056
    v_exp_f32 v130, v130
    v_exp_f32 v131, v131
    v_perm_b32 v152, v129, v128, s28
    v_mfma_f32_32x32x16_bf16 v[112:127], v[164:167], v[84:87], v[112:127]
    ds_read_b128 v[180:183], v3 offset:45056
    v_exp_f32 v132, v132
    v_exp_f32 v133, v133
    v_perm_b32 v153, v131, v130, s28
    v_mfma_f32_32x32x16_bf16 v[112:127], v[168:171], v[88:91], v[112:127]
    ds_read_b128 v[184:187], v4 offset:45056
    v_exp_f32 v134, v134
    v_exp_f32 v135, v135
    v_perm_b32 v154, v133, v132, s28
    v_mfma_f32_32x32x16_bf16 v[112:127], v[172:175], v[92:95], v[112:127]
    s_waitcnt lgkmcnt(3)
    v_exp_f32 v136, v136
    v_exp_f32 v137, v137
    v_perm_b32 v155, v135, v134, s28
    v_mfma_f32_32x32x16_bf16 v[16:31], v[208:211], v[144:147], v[16:31]
    ds_read_b128 v[188:191], v5 offset:45056
    v_exp_f32 v138, v138
    v_exp_f32 v139, v139
    v_perm_b32 v156, v137, v136, s28
    v_mfma_f32_32x32x16_bf16 v[32:47], v[212:215], v[144:147], v[32:47]
    ds_read_b64_tr_b16 v[192:193], v6 offset:40960
    v_exp_f32 v140, v140
    v_exp_f32 v141, v141
    v_perm_b32 v157, v139, v138, s28
    v_mfma_f32_32x32x16_bf16 v[16:31], v[216:219], v[148:151], v[16:31]
    ds_read_b64_tr_b16 v[194:195], v7 offset:40960
    v_exp_f32 v142, v142
    v_exp_f32 v143, v143
    v_perm_b32 v158, v141, v140, s28
    v_mfma_f32_32x32x16_bf16 v[32:47], v[220:223], v[148:151], v[32:47]
    ds_read_b64_tr_b16 v[196:197], v8 offset:40960
    v_exp_f32 v112, v112
    v_exp_f32 v113, v113
    v_perm_b32 v159, v143, v142, s28
    v_mfma_f32_32x32x16_bf16 v[128:143], v[160:163], v[96:99], 0
    ds_read_b64_tr_b16 v[198:199], v9 offset:40960
    v_exp_f32 v114, v114
    v_exp_f32 v115, v115
    v_perm_b32 v144, v113, v112, s28
    v_mfma_f32_32x32x16_bf16 v[128:143], v[164:167], v[100:103], v[128:143]
    ds_read_b64_tr_b16 v[200:201], v6 offset:43008
    v_exp_f32 v116, v116
    v_exp_f32 v117, v117
    v_perm_b32 v145, v115, v114, s28
    v_mfma_f32_32x32x16_bf16 v[128:143], v[168:171], v[104:107], v[128:143]
    ds_read_b64_tr_b16 v[202:203], v7 offset:43008
    v_exp_f32 v118, v118
    v_exp_f32 v119, v119
    v_perm_b32 v146, v117, v116, s28
    v_mfma_f32_32x32x16_bf16 v[128:143], v[172:175], v[108:111], v[128:143]
    ds_read_b64_tr_b16 v[204:205], v8 offset:43008
    v_exp_f32 v120, v120
    v_exp_f32 v121, v121
    v_perm_b32 v147, v119, v118, s28
    v_mfma_f32_32x32x16_bf16 v[48:63], v[208:211], v[152:155], v[48:63]
    ds_read_b64_tr_b16 v[206:207], v9 offset:43008
    v_exp_f32 v122, v122
    v_exp_f32 v123, v123
    v_perm_b32 v148, v121, v120, s28
    v_mfma_f32_32x32x16_bf16 v[64:79], v[212:215], v[152:155], v[64:79]
    v_exp_f32 v124, v124
    v_exp_f32 v125, v125
    v_perm_b32 v149, v123, v122, s28
    v_mfma_f32_32x32x16_bf16 v[48:63], v[216:219], v[156:159], v[48:63]
    s_waitcnt lgkmcnt(8)
    v_exp_f32 v126, v126
    v_exp_f32 v127, v127
    v_perm_b32 v150, v125, v124, s28
    v_mfma_f32_32x32x16_bf16 v[64:79], v[220:223], v[156:159], v[64:79]
    v_exp_f32 v128, v128
    v_exp_f32 v129, v129
    v_perm_b32 v151, v127, v126, s28
    v_mfma_f32_32x32x16_bf16 v[112:127], v[176:179], v[80:83], 0
    ds_read_b128 v[160:163], v2 offset:49152
    v_exp_f32 v130, v130
    v_exp_f32 v131, v131
    v_perm_b32 v152, v129, v128, s28
    v_mfma_f32_32x32x16_bf16 v[112:127], v[180:183], v[84:87], v[112:127]
    ds_read_b128 v[164:167], v3 offset:49152
    v_exp_f32 v132, v132
    v_exp_f32 v133, v133
    v_perm_b32 v153, v131, v130, s28
    v_mfma_f32_32x32x16_bf16 v[112:127], v[184:187], v[88:91], v[112:127]
    ds_read_b128 v[168:171], v4 offset:49152
    v_exp_f32 v134, v134
    v_exp_f32 v135, v135
    v_perm_b32 v154, v133, v132, s28
    v_mfma_f32_32x32x16_bf16 v[112:127], v[188:191], v[92:95], v[112:127]
    s_waitcnt lgkmcnt(3)
    v_exp_f32 v136, v136
    v_exp_f32 v137, v137
    v_perm_b32 v155, v135, v134, s28
    v_mfma_f32_32x32x16_bf16 v[16:31], v[192:195], v[144:147], v[16:31]
    ds_read_b128 v[172:175], v5 offset:49152
    v_exp_f32 v138, v138
    v_exp_f32 v139, v139
    v_perm_b32 v156, v137, v136, s28
    v_mfma_f32_32x32x16_bf16 v[32:47], v[196:199], v[144:147], v[32:47]
    ds_read_b64_tr_b16 v[208:209], v6 offset:45056
    v_exp_f32 v140, v140
    v_exp_f32 v141, v141
    v_perm_b32 v157, v139, v138, s28
    v_mfma_f32_32x32x16_bf16 v[16:31], v[200:203], v[148:151], v[16:31]
    ds_read_b64_tr_b16 v[210:211], v7 offset:45056
    v_exp_f32 v142, v142
    v_exp_f32 v143, v143
    v_perm_b32 v158, v141, v140, s28
    v_mfma_f32_32x32x16_bf16 v[32:47], v[204:207], v[148:151], v[32:47]
    ds_read_b64_tr_b16 v[212:213], v8 offset:45056
    v_exp_f32 v112, v112
    v_exp_f32 v113, v113
    v_perm_b32 v159, v143, v142, s28
    v_mfma_f32_32x32x16_bf16 v[128:143], v[176:179], v[96:99], 0
    ds_read_b64_tr_b16 v[214:215], v9 offset:45056
    v_exp_f32 v114, v114
    v_exp_f32 v115, v115
    v_perm_b32 v144, v113, v112, s28
    v_mfma_f32_32x32x16_bf16 v[128:143], v[180:183], v[100:103], v[128:143]
    ds_read_b64_tr_b16 v[216:217], v6 offset:47104
    v_exp_f32 v116, v116
    v_exp_f32 v117, v117
    v_perm_b32 v145, v115, v114, s28
    v_mfma_f32_32x32x16_bf16 v[128:143], v[184:187], v[104:107], v[128:143]
    ds_read_b64_tr_b16 v[218:219], v7 offset:47104
    v_exp_f32 v118, v118
    v_exp_f32 v119, v119
    v_perm_b32 v146, v117, v116, s28
    v_mfma_f32_32x32x16_bf16 v[128:143], v[188:191], v[108:111], v[128:143]
    ds_read_b64_tr_b16 v[220:221], v8 offset:47104
    v_exp_f32 v120, v120
    v_exp_f32 v121, v121
    v_perm_b32 v147, v119, v118, s28
    v_mfma_f32_32x32x16_bf16 v[48:63], v[192:195], v[152:155], v[48:63]
    ds_read_b64_tr_b16 v[222:223], v9 offset:47104
    v_exp_f32 v122, v122
    v_exp_f32 v123, v123
    v_perm_b32 v148, v121, v120, s28
    v_mfma_f32_32x32x16_bf16 v[64:79], v[196:199], v[152:155], v[64:79]
    s_barrier
    v_exp_f32 v124, v124
    v_exp_f32 v125, v125
    v_perm_b32 v149, v123, v122, s28
    v_mfma_f32_32x32x16_bf16 v[48:63], v[200:203], v[156:159], v[48:63]
    s_waitcnt lgkmcnt(8)
    v_exp_f32 v126, v126
    v_exp_f32 v127, v127
    v_perm_b32 v150, v125, v124, s28
    v_mfma_f32_32x32x16_bf16 v[64:79], v[204:207], v[156:159], v[64:79]
    v_exp_f32 v128, v128
    v_exp_f32 v129, v129
    v_perm_b32 v151, v127, v126, s28
    v_mfma_f32_32x32x16_bf16 v[112:127], v[160:163], v[80:83], 0
    ds_read_b128 v[176:179], v2 offset:53248
    v_exp_f32 v130, v130
    v_exp_f32 v131, v131
    v_perm_b32 v152, v129, v128, s28
    v_mfma_f32_32x32x16_bf16 v[112:127], v[164:167], v[84:87], v[112:127]
    ds_read_b128 v[180:183], v3 offset:53248
    v_exp_f32 v132, v132
    v_exp_f32 v133, v133
    v_perm_b32 v153, v131, v130, s28
    v_mfma_f32_32x32x16_bf16 v[112:127], v[168:171], v[88:91], v[112:127]
    ds_read_b128 v[184:187], v4 offset:53248
    v_exp_f32 v134, v134
    v_exp_f32 v135, v135
    v_perm_b32 v154, v133, v132, s28
    v_mfma_f32_32x32x16_bf16 v[112:127], v[172:175], v[92:95], v[112:127]
    s_waitcnt lgkmcnt(3)
    v_exp_f32 v136, v136
    v_exp_f32 v137, v137
    v_perm_b32 v155, v135, v134, s28
    v_mfma_f32_32x32x16_bf16 v[16:31], v[208:211], v[144:147], v[16:31]
    ds_read_b128 v[188:191], v5 offset:53248
    v_exp_f32 v138, v138
    v_exp_f32 v139, v139
    v_perm_b32 v156, v137, v136, s28
    v_mfma_f32_32x32x16_bf16 v[32:47], v[212:215], v[144:147], v[32:47]
    ds_read_b64_tr_b16 v[192:193], v6 offset:49152
    v_exp_f32 v140, v140
    v_exp_f32 v141, v141
    v_perm_b32 v157, v139, v138, s28
    v_mfma_f32_32x32x16_bf16 v[16:31], v[216:219], v[148:151], v[16:31]
    ds_read_b64_tr_b16 v[194:195], v7 offset:49152
    v_exp_f32 v142, v142
    v_exp_f32 v143, v143
    v_perm_b32 v158, v141, v140, s28
    v_mfma_f32_32x32x16_bf16 v[32:47], v[220:223], v[148:151], v[32:47]
    ds_read_b64_tr_b16 v[196:197], v8 offset:49152
    v_exp_f32 v112, v112
    v_exp_f32 v113, v113
    v_perm_b32 v159, v143, v142, s28
    v_mfma_f32_32x32x16_bf16 v[128:143], v[160:163], v[96:99], 0
    ds_read_b64_tr_b16 v[198:199], v9 offset:49152
    v_exp_f32 v114, v114
    v_exp_f32 v115, v115
    v_perm_b32 v144, v113, v112, s28
    v_mfma_f32_32x32x16_bf16 v[128:143], v[164:167], v[100:103], v[128:143]
    ds_read_b64_tr_b16 v[200:201], v6 offset:51200
    v_exp_f32 v116, v116
    v_exp_f32 v117, v117
    v_perm_b32 v145, v115, v114, s28
    v_mfma_f32_32x32x16_bf16 v[128:143], v[168:171], v[104:107], v[128:143]
    ds_read_b64_tr_b16 v[202:203], v7 offset:51200
    v_exp_f32 v118, v118
    v_exp_f32 v119, v119
    v_perm_b32 v146, v117, v116, s28
    v_mfma_f32_32x32x16_bf16 v[128:143], v[172:175], v[108:111], v[128:143]
    ds_read_b64_tr_b16 v[204:205], v8 offset:51200
    v_exp_f32 v120, v120
    v_exp_f32 v121, v121
    v_perm_b32 v147, v119, v118, s28
    v_mfma_f32_32x32x16_bf16 v[48:63], v[208:211], v[152:155], v[48:63]
    ds_read_b64_tr_b16 v[206:207], v9 offset:51200
    v_exp_f32 v122, v122
    v_exp_f32 v123, v123
    v_perm_b32 v148, v121, v120, s28
    v_mfma_f32_32x32x16_bf16 v[64:79], v[212:215], v[152:155], v[64:79]
    v_exp_f32 v124, v124
    v_exp_f32 v125, v125
    v_perm_b32 v149, v123, v122, s28
    v_mfma_f32_32x32x16_bf16 v[48:63], v[216:219], v[156:159], v[48:63]
    s_sub_u32 s12, s12, 1
    s_waitcnt lgkmcnt(8)
    v_exp_f32 v126, v126
    v_exp_f32 v127, v127
    v_perm_b32 v150, v125, v124, s28
    v_mfma_f32_32x32x16_bf16 v[64:79], v[220:223], v[156:159], v[64:79]
    s_cbranch_scc1 K2_E0
    v_exp_f32 v128, v128
    v_exp_f32 v129, v129
    v_perm_b32 v151, v127, v126, s28
    v_mfma_f32_32x32x16_bf16 v[112:127], v[176:179], v[80:83], 0
    ds_read_b128 v[160:163], v2 offset:57344
    v_exp_f32 v130, v130
    v_exp_f32 v131, v131
    v_perm_b32 v152, v129, v128, s28
    v_mfma_f32_32x32x16_bf16 v[112:127], v[180:183], v[84:87], v[112:127]
    ds_read_b128 v[164:167], v3 offset:57344
    v_exp_f32 v132, v132
    v_exp_f32 v133, v133
    v_perm_b32 v153, v131, v130, s28
    v_mfma_f32_32x32x16_bf16 v[112:127], v[184:187], v[88:91], v[112:127]
    ds_read_b128 v[168:171], v4 offset:57344
    v_exp_f32 v134, v134
    v_exp_f32 v135, v135
    v_perm_b32 v154, v133, v132, s28
    v_mfma_f32_32x32x16_bf16 v[112:127], v[188:191], v[92:95], v[112:127]
    s_waitcnt lgkmcnt(3)
    v_exp_f32 v136, v136
    v_exp_f32 v137, v137
    v_perm_b32 v155, v135, v134, s28
    v_mfma_f32_32x32x16_bf16 v[16:31], v[192:195], v[144:147], v[16:31]
    ds_read_b128 v[172:175], v5 offset:57344
    v_exp_f32 v138, v138
    v_exp_f32 v139, v139
    v_perm_b32 v156, v137, v136, s28
    v_mfma_f32_32x32x16_bf16 v[32:47], v[196:199], v[144:147], v[32:47]
    ds_read_b64_tr_b16 v[208:209], v6 offset:53248
    v_exp_f32 v140, v140
    v_exp_f32 v141, v141
    v_perm_b32 v157, v139, v138, s28
    v_mfma_f32_32x32x16_bf16 v[16:31], v[200:203], v[148:151], v[16:31]
    ds_read_b64_tr_b16 v[210:211], v7 offset:53248
    v_exp_f32 v142, v142
    v_exp_f32 v143, v143
    v_perm_b32 v158, v141, v140, s28
    v_mfma_f32_32x32x16_bf16 v[32:47], v[204:207], v[148:151], v[32:47]
    ds_read_b64_tr_b16 v[212:213], v8 offset:53248
    v_exp_f32 v112, v112
    v_exp_f32 v113, v113
    v_perm_b32 v159, v143, v142, s28
    v_mfma_f32_32x32x16_bf16 v[128:143], v[176:179], v[96:99], 0
    ds_read_b64_tr_b16 v[214:215], v9 offset:53248
    v_exp_f32 v114, v114
    v_exp_f32 v115, v115
    v_perm_b32 v144, v113, v112, s28
    v_mfma_f32_32x32x16_bf16 v[128:143], v[180:183], v[100:103], v[128:143]
    ds_read_b64_tr_b16 v[216:217], v6 offset:55296
    v_exp_f32 v116, v116
    v_exp_f32 v117, v117
    v_perm_b32 v145, v115, v114, s28
    v_mfma_f32_32x32x16_bf16 v[128:143], v[184:187], v[104:107], v[128:143]
    ds_read_b64_tr_b16 v[218:219], v7 offset:55296
    v_exp_f32 v118, v118
    v_exp_f32 v119, v119
    v_perm_b32 v146, v117, v116, s28
    v_mfma_f32_32x32x16_bf16 v[128:143], v[188:191], v[108:111], v[128:143]
    ds_read_b64_tr_b16 v[220:221], v8 offset:55296
    v_exp_f32 v120, v120
    v_exp_f32 v121, v121
    v_perm_b32 v147, v119, v118, s28
    v_mfma_f32_32x32x16_bf16 v[48:63], v[192:195], v[152:155], v[48:63]
    ds_read_b64_tr_b16 v[222:223], v9 offset:55296
    v_exp_f32 v122, v122
    v_exp_f32 v123, v123
    v_perm_b32 v148, v121, v120, s28
    v_mfma_f32_32x32x16_bf16 v[64:79], v[196:199], v[152:155], v[64:79]
    s_barrier
    v_exp_f32 v124, v124
    v_exp_f32 v125, v125
    v_perm_b32 v149, v123, v122, s28
    v_mfma_f32_32x32x16_bf16 v[48:63], v[200:203], v[156:159], v[48:63]
    s_waitcnt lgkmcnt(8)
    v_exp_f32 v126, v126
    v_exp_f32 v127, v127
    v_perm_b32 v150, v125, v124, s28
    v_mfma_f32_32x32x16_bf16 v[64:79], v[204:207], v[156:159], v[64:79]
    v_exp_f32 v128, v128
    v_exp_f32 v129, v129
    v_perm_b32 v151, v127, v126, s28
    v_mfma_f32_32x32x16_bf16 v[112:127], v[160:163], v[80:83], 0
    ds_read_b128 v[176:179], v2 offset:61440
    v_exp_f32 v130, v130
    v_exp_f32 v131, v131
    v_perm_b32 v152, v129, v128, s28
    v_mfma_f32_32x32x16_bf16 v[112:127], v[164:167], v[84:87], v[112:127]
    ds_read_b128 v[180:183], v3 offset:61440
    v_exp_f32 v132, v132
    v_exp_f32 v133, v133
    v_perm_b32 v153, v131, v130, s28
    v_mfma_f32_32x32x16_bf16 v[112:127], v[168:171], v[88:91], v[112:127]
    ds_read_b128 v[184:187], v4 offset:61440
    v_exp_f32 v134, v134
    v_exp_f32 v135, v135
    v_perm_b32 v154, v133, v132, s28
    v_mfma_f32_32x32x16_bf16 v[112:127], v[172:175], v[92:95], v[112:127]
    s_waitcnt lgkmcnt(3)
    v_exp_f32 v136, v136
    v_exp_f32 v137, v137
    v_perm_b32 v155, v135, v134, s28
    v_mfma_f32_32x32x16_bf16 v[16:31], v[208:211], v[144:147], v[16:31]
    ds_read_b128 v[188:191], v5 offset:61440
    v_exp_f32 v138, v138
    v_exp_f32 v139, v139
    v_perm_b32 v156, v137, v136, s28
    v_mfma_f32_32x32x16_bf16 v[32:47], v[212:215], v[144:147], v[32:47]
    ds_read_b64_tr_b16 v[192:193], v6 offset:57344
    v_exp_f32 v140, v140
    v_exp_f32 v141, v141
    v_perm_b32 v157, v139, v138, s28
    v_mfma_f32_32x32x16_bf16 v[16:31], v[216:219], v[148:151], v[16:31]
    ds_read_b64_tr_b16 v[194:195], v7 offset:57344
    v_exp_f32 v142, v142
    v_exp_f32 v143, v143
    v_perm_b32 v158, v141, v140, s28
    v_mfma_f32_32x32x16_bf16 v[32:47], v[220:223], v[148:151], v[32:47]
    ds_read_b64_tr_b16 v[196:197], v8 offset:57344
    v_exp_f32 v112, v112
    v_exp_f32 v113, v113
    v_perm_b32 v159, v143, v142, s28
    v_mfma_f32_32x32x16_bf16 v[128:143], v[160:163], v[96:99], 0
    ds_read_b64_tr_b16 v[198:199], v9 offset:57344
    v_exp_f32 v114, v114
    v_exp_f32 v115, v115
    v_perm_b32 v144, v113, v112, s28
    v_mfma_f32_32x32x16_bf16 v[128:143], v[164:167], v[100:103], v[128:143]
    ds_read_b64_tr_b16 v[200:201], v6 offset:59392
    v_exp_f32 v116, v116
    v_exp_f32 v117, v117
    v_perm_b32 v145, v115, v114, s28
    v_mfma_f32_32x32x16_bf16 v[128:143], v[168:171], v[104:107], v[128:143]
    ds_read_b64_tr_b16 v[202:203], v7 offset:59392
    v_exp_f32 v118, v118
    v_exp_f32 v119, v119
    v_perm_b32 v146, v117, v116, s28
    v_mfma_f32_32x32x16_bf16 v[128:143], v[172:175], v[108:111], v[128:143]
    ds_read_b64_tr_b16 v[204:205], v8 offset:59392
    v_exp_f32 v120, v120
    v_exp_f32 v121, v121
    v_perm_b32 v147, v119, v118, s28
    v_mfma_f32_32x32x16_bf16 v[48:63], v[208:211], v[152:155], v[48:63]
    ds_read_b64_tr_b16 v[206:207], v9 offset:59392
    v_exp_f32 v122, v122
    v_exp_f32 v123, v123
    v_perm_b32 v148, v121, v120, s28
    v_mfma_f32_32x32x16_bf16 v[64:79], v[212:215], v[152:155], v[64:79]
    v_exp_f32 v124, v124
    v_exp_f32 v125, v125
    v_perm_b32 v149, v123, v122, s28
    v_mfma_f32_32x32x16_bf16 v[48:63], v[216:219], v[156:159], v[48:63]
    s_waitcnt lgkmcnt(8)
    v_exp_f32 v126, v126
    v_exp_f32 v127, v127
    v_perm_b32 v150, v125, v124, s28
    v_mfma_f32_32x32x16_bf16 v[64:79], v[220:223], v[156:159], v[64:79]
    v_exp_f32 v128, v128
    v_exp_f32 v129, v129
    v_perm_b32 v151, v127, v126, s28
    v_mfma_f32_32x32x16_bf16 v[112:127], v[176:179], v[80:83], 0
    ds_read_b128 v[160:163], v2 offset:0
    v_exp_f32 v130, v130
    v_exp_f32 v131, v131
    v_perm_b32 v152, v129, v128, s28
    v_mfma_f32_32x32x16_bf16 v[112:127], v[180:183], v[84:87], v[112:127]
    ds_read_b128 v[164:167], v3 offset:0
    v_exp_f32 v132, v132
    v_exp_f32 v133, v133
    v_perm_b32 v153, v131, v130, s28
    v_mfma_f32_32x32x16_bf16 v[112:127], v[184:187], v[88:91], v[112:127]
    ds_read_b128 v[168:171], v4 offset:0
    v_exp_f32 v134, v134
    v_exp_f32 v135, v135
    v_perm_b32 v154, v133, v132, s28
    v_mfma_f32_32x32x16_bf16 v[112:127], v[188:191], v[92:95], v[112:127]
    s_waitcnt lgkmcnt(3)
    v_exp_f32 v136, v136
    v_exp_f32 v137, v137
    v_perm_b32 v155, v135, v134, s28
    v_mfma_f32_32x32x16_bf16 v[16:31], v[192:195], v[144:147], v[16:31]
    ds_read_b128 v[172:175], v5 offset:0
    v_exp_f32 v138, v138
    v_exp_f32 v139, v139
    v_perm_b32 v156, v137, v136, s28
    v_mfma_f32_32x32x16_bf16 v[32:47], v[196:199], v[144:147], v[32:47]
    ds_read_b64_tr_b16 v[208:209], v6 offset:61440
    v_exp_f32 v140, v140
    v_exp_f32 v141, v141
    v_perm_b32 v157, v139, v138, s28
    v_mfma_f32_32x32x16_bf16 v[16:31], v[200:203], v[148:151], v[16:31]
    ds_read_b64_tr_b16 v[210:211], v7 offset:61440
    v_exp_f32 v142, v142
    v_exp_f32 v143, v143
    v_perm_b32 v158, v141, v140, s28
    v_mfma_f32_32x32x16_bf16 v[32:47], v[204:207], v[148:151], v[32:47]
    ds_read_b64_tr_b16 v[212:213], v8 offset:61440
    v_exp_f32 v112, v112
    v_exp_f32 v113, v113
    v_perm_b32 v159, v143, v142, s28
    v_mfma_f32_32x32x16_bf16 v[128:143], v[176:179], v[96:99], 0
    ds_read_b64_tr_b16 v[214:215], v9 offset:61440
    v_exp_f32 v114, v114
    v_exp_f32 v115, v115
    v_perm_b32 v144, v113, v112, s28
    v_mfma_f32_32x32x16_bf16 v[128:143], v[180:183], v[100:103], v[128:143]
    ds_read_b64_tr_b16 v[216:217], v6 offset:63488
    v_exp_f32 v116, v116
    v_exp_f32 v117, v117
    v_perm_b32 v145, v115, v114, s28
    v_mfma_f32_32x32x16_bf16 v[128:143], v[184:187], v[104:107], v[128:143]
    ds_read_b64_tr_b16 v[218:219], v7 offset:63488
    v_exp_f32 v118, v118
    v_exp_f32 v119, v119
    v_perm_b32 v146, v117, v116, s28
    v_mfma_f32_32x32x16_bf16 v[128:143], v[188:191], v[108:111], v[128:143]
    ds_read_b64_tr_b16 v[220:221], v8 offset:63488
    v_exp_f32 v120, v120
    v_exp_f32 v121, v121
    v_perm_b32 v147, v119, v118, s28
    v_mfma_f32_32x32x16_bf16 v[48:63], v[192:195], v[152:155], v[48:63]
    ds_read_b64_tr_b16 v[222:223], v9 offset:63488
    v_exp_f32 v122, v122
    v_exp_f32 v123, v123
    v_perm_b32 v148, v121, v120, s28
    v_mfma_f32_32x32x16_bf16 v[64:79], v[196:199], v[152:155], v[64:79]
    s_barrier
    v_exp_f32 v124, v124
    v_exp_f32 v125, v125
    v_perm_b32 v149, v123, v122, s28
    v_mfma_f32_32x32x16_bf16 v[48:63], v[200:203], v[156:159], v[48:63]
    s_waitcnt lgkmcnt(8)
    v_exp_f32 v126, v126
    v_exp_f32 v127, v127
    v_perm_b32 v150, v125, v124, s28
    v_mfma_f32_32x32x16_bf16 v[64:79], v[204:207], v[156:159], v[64:79]
    s_branch K2_TOP
K2_E0:
    s_waitcnt lgkmcnt(0)
    v_exp_f32 v128, v128
    v_exp_f32 v129, v129
    v_perm_b32 v151, v127, v126, s28
    v_mfma_f32_32x32x16_bf16 v[16:31], v[192:195], v[144:147], v[16:31]
    v_exp_f32 v130, v130
    v_exp_f32 v131, v131
    v_perm_b32 v152, v129, v128, s28
    v_mfma_f32_32x32x16_bf16 v[32:47], v[196:199], v[144:147], v[32:47]
    v_exp_f32 v132, v132
    v_exp_f32 v133, v133
    v_perm_b32 v153, v131, v130, s28
    v_mfma_f32_32x32x16_bf16 v[16:31], v[200:203], v[148:151], v[16:31]
    v_exp_f32 v134, v134
    v_exp_f32 v135, v135
    v_perm_b32 v154, v133, v132, s28
    v_mfma_f32_32x32x16_bf16 v[32:47], v[204:207], v[148:151], v[32:47]
    v_exp_f32 v136, v136
    v_exp_f32 v137, v137
    v_perm_b32 v155, v135, v134, s28
    v_exp_f32 v138, v138
    v_exp_f32 v139, v139
    v_perm_b32 v156, v137, v136, s28
    v_mfma_f32_32x32x16_bf16 v[48:63], v[192:195], v[152:155], v[48:63]
    v_exp_f32 v140, v140
    v_exp_f32 v141, v141
    v_perm_b32 v157, v139, v138, s28
    v_mfma_f32_32x32x16_bf16 v[64:79], v[196:199], v[152:155], v[64:79]
    v_exp_f32 v142, v142
    v_exp_f32 v143, v143
    v_perm_b32 v158, v141, v140, s28
    v_perm_b32 v159, v143, v142, s28
    s_nop 1
    v_mfma_f32_32x32x16_bf16 v[48:63], v[200:203], v[156:159], v[48:63]
    v_cvt_pk_bf16_f32 v112, v16, v17
    v_cvt_pk_bf16_f32 v113, v18, v19
    v_cvt_pk_bf16_f32 v114, v20, v21
    v_cvt_pk_bf16_f32 v115, v22, v23
    buffer_store_dwordx4 v[112:115], v10, s[16:19], s20 offen offset:0 sc0 sc1
    v_mfma_f32_32x32x16_bf16 v[64:79], v[204:207], v[156:159], v[64:79]
    v_cvt_pk_bf16_f32 v116, v24, v25
    v_cvt_pk_bf16_f32 v117, v26, v27
    v_cvt_pk_bf16_f32 v118, v28, v29
    v_cvt_pk_bf16_f32 v119, v30, v31
    buffer_store_dwordx4 v[116:119], v10, s[16:19], s20 offen offset:1024 sc0 sc1
    v_cvt_pk_bf16_f32 v120, v32, v33
    v_cvt_pk_bf16_f32 v121, v34, v35
    v_cvt_pk_bf16_f32 v122, v36, v37
    v_cvt_pk_bf16_f32 v123, v38, v39
    buffer_store_dwordx4 v[120:123], v10, s[16:19], s20 offen offset:2048 sc0 sc1
    v_cvt_pk_bf16_f32 v124, v40, v41
    v_cvt_pk_bf16_f32 v125, v42, v43
    v_cvt_pk_bf16_f32 v126, v44, v45
    v_cvt_pk_bf16_f32 v127, v46, v47
    buffer_store_dwordx4 v[124:127], v10, s[16:19], s20 offen offset:3072 sc0 sc1
    s_branch K2_EPI
K2_E1:
    s_waitcnt lgkmcnt(0)
    v_exp_f32 v128, v128
    v_exp_f32 v129, v129
    v_perm_b32 v151, v127, v126, s28
    v_mfma_f32_32x32x16_bf16 v[16:31], v[208:211], v[144:147], v[16:31]
    v_exp_f32 v130, v130
    v_exp_f32 v131, v131
    v_perm_b32 v152, v129, v128, s28
    v_mfma_f32_32x32x16_bf16 v[32:47], v[212:215], v[144:147], v[32:47]
    v_exp_f32 v132, v132
    v_exp_f32 v133, v133
    v_perm_b32 v153, v131, v130, s28
    v_mfma_f32_32x32x16_bf16 v[16:31], v[216:219], v[148:151], v[16:31]
    v_exp_f32 v134, v134
    v_exp_f32 v135, v135
    v_perm_b32 v154, v133, v132, s28
    v_mfma_f32_32x32x16_bf16 v[32:47], v[220:223], v[148:151], v[32:47]
    v_exp_f32 v136, v136
    v_exp_f32 v137, v137
    v_perm_b32 v155, v135, v134, s28
    v_exp_f32 v138, v138
    v_exp_f32 v139, v139
    v_perm_b32 v156, v137, v136, s28
    v_mfma_f32_32x32x16_bf16 v[48:63], v[208:211], v[152:155], v[48:63]
    v_exp_f32 v140, v140
    v_exp_f32 v141, v141
    v_perm_b32 v157, v139, v138, s28
    v_mfma_f32_32x32x16_bf16 v[64:79], v[212:215], v[152:155], v[64:79]
    v_exp_f32 v142, v142
    v_exp_f32 v143, v143
    v_perm_b32 v158, v141, v140, s28
    v_perm_b32 v159, v143, v142, s28
    s_nop 1
    v_mfma_f32_32x32x16_bf16 v[48:63], v[216:219], v[156:159], v[48:63]
    v_cvt_pk_bf16_f32 v112, v16, v17
    v_cvt_pk_bf16_f32 v113, v18, v19
    v_cvt_pk_bf16_f32 v114, v20, v21
    v_cvt_pk_bf16_f32 v115, v22, v23
    buffer_store_dwordx4 v[112:115], v10, s[16:19], s20 offen offset:0 sc0 sc1
    v_mfma_f32_32x32x16_bf16 v[64:79], v[220:223], v[156:159], v[64:79]
    v_cvt_pk_bf16_f32 v116, v24, v25
    v_cvt_pk_bf16_f32 v117, v26, v27
    v_cvt_pk_bf16_f32 v118, v28, v29
    v_cvt_pk_bf16_f32 v119, v30, v31
    buffer_store_dwordx4 v[116:119], v10, s[16:19], s20 offen offset:1024 sc0 sc1
    v_cvt_pk_bf16_f32 v120, v32, v33
    v_cvt_pk_bf16_f32 v121, v34, v35
    v_cvt_pk_bf16_f32 v122, v36, v37
    v_cvt_pk_bf16_f32 v123, v38, v39
    buffer_store_dwordx4 v[120:123], v10, s[16:19], s20 offen offset:2048 sc0 sc1
    v_cvt_pk_bf16_f32 v124, v40, v41
    v_cvt_pk_bf16_f32 v125, v42, v43
    v_cvt_pk_bf16_f32 v126, v44, v45
    v_cvt_pk_bf16_f32 v127, v46, v47
    buffer_store_dwordx4 v[124:127], v10, s[16:19], s20 offen offset:3072 sc0 sc1
K2_EPI:
    v_cvt_pk_bf16_f32 v160, v48, v49
    v_cvt_pk_bf16_f32 v161, v50, v51
    v_cvt_pk_bf16_f32 v162, v52, v53
    v_cvt_pk_bf16_f32 v163, v54, v55
    buffer_store_dwordx4 v[160:163], v10, s[16:19], s21 offen offset:0 sc0 sc1
    v_cvt_pk_bf16_f32 v164, v56, v57
    v_cvt_pk_bf16_f32 v165, v58, v59
    v_cvt_pk_bf16_f32 v166, v60, v61
    v_cvt_pk_bf16_f32 v167, v62, v63
    buffer_store_dwordx4 v[164:167], v10, s[16:19], s21 offen offset:1024 sc0 sc1
    v_cvt_pk_bf16_f32 v168, v64, v65
    v_cvt_pk_bf16_f32 v169, v66, v67
    v_cvt_pk_bf16_f32 v170, v68, v69
    v_cvt_pk_bf16_f32 v171, v70, v71
    buffer_store_dwordx4 v[168:171], v10, s[16:19], s21 offen offset:2048 sc0 sc1
    v_cvt_pk_bf16_f32 v172, v72, v73
    v_cvt_pk_bf16_f32 v173, v74, v75
    v_cvt_pk_bf16_f32 v174, v76, v77
    v_cvt_pk_bf16_f32 v175, v78, v79
    buffer_store_dwordx4 v[172:175], v10, s[16:19], s21 offen offset:3072 sc0 sc1
    s_mov_b32 exec_lo, 0
    buffer_store_dword v47, v11, s[24:27], s22 offen offset:0 sc0 sc1
    buffer_store_dword v79, v11, s[24:27], s22 offen offset:128 sc0 sc1
    s_mov_b64 exec, -1
    s_branch K2_FIN
K2_AUX:
    s_setprio 3
    s_sub_u32 s13, s3, 4
    s_lshl_b32 s15, s13, 10
    s_add_u32 s66, s15, 143136
    s_mov_b32 s67, 0xffff
    v_and_b32 v1, 63, v0
    v_lshlrev_b32 v2, 4, v1
    v_add_u32 v2, s15, v2
    s_lshl_b32 s41, s10, 12
    s_add_u32 s41, s41, 0x0
    s_lshl_b32 s42, s11, 12
    s_mov_b32 s14, 0
    s_mov_b32 s40, 0
    s_mul_i32 s43, s2, 13088
    s_sub_u32 s44, 3200000, s43
    s_min_u32 s44, s44, 13088
    s_waitcnt lgkmcnt(0)
    s_add_u32 s16, s4, s41
    s_addc_u32 s17, s5, 0
    s_mov_b32 s18, s42
    s_mov_b32 s19, 0x00020000
    s_and_b32 s41, s14, s67
    s_add_u32 m0, s41, s15
    s_nop 0
    buffer_load_dwordx4 v2, s[16:19], s14 offen lds
    s_add_u32 s14, s14, 0x1000
    s_and_b32 s41, s14, s67
    s_add_u32 m0, s41, s15
    s_nop 0
    buffer_load_dwordx4 v2, s[16:19], s14 offen lds
    s_add_u32 s14, s14, 0x1000
    s_and_b32 s41, s14, s67
    s_add_u32 m0, s41, s15
    s_nop 0
    buffer_load_dwordx4 v2, s[16:19], s14 offen lds
    s_add_u32 s14, s14, 0x1000
    s_add_u32 s20, s94, s43
    s_addc_u32 s21, s95, 0
    s_mov_b32 s22, s44
    s_mov_b32 s23, 0x00020000
    s_add_u32 s24, s92, s43
    s_addc_u32 s25, s93, 0
    s_mov_b32 s26, s44
    s_mov_b32 s27, 0x00020000
    s_lshl_b32 s41, s64, 13
    s_add_u32 s41, s41, 0x4b0000
    s_add_u32 s28, s4, s41
    s_addc_u32 s29, s5, 0
    s_mov_b32 s30, 0x2000
    s_mov_b32 s31, 0x00020000
    s_mov_b32 s32, s6
    s_mov_b32 s33, s7
    s_mov_b32 s34, 0x61a8
    s_mov_b32 s35, 0x00020000
    v_mov_b32 v12, -1
    v_mov_b32 v13, -1
    v_mov_b32 v14, -1
    v_mov_b32 v15, -1
    v_add_u32 v11, 66048, v2
    ds_write_b128 v11, v[12:15] offset:0
    ds_write_b128 v11, v[12:15] offset:4096
    ds_write_b128 v11, v[12:15] offset:8192
    ds_write_b128 v11, v[12:15] offset:12288
    v_lshlrev_b32 v52, 4, v1
    v_add_u32 v52, 66048, v52
    ds_write_b128 v52, v[12:15] offset:16384
    v_mul_u32_u24 v12, 260, v1
    v_add_u32 v12, 66048, v12
    v_lshlrev_b32 v52, 2, v1
    v_add_u32 v52, 65536, v52
    ds_write_b32 v52, v12
    v_mov_b32 v53, 65536
    v_mov_b32 v12, 0
    v_mov_b32 v13, 0
    v_mov_b32 v14, 0
    v_mov_b32 v15, 0
    ds_write_b128 v53, v[12:15] offset:256
    v_lshrrev_b32 v4, 2, v2
    v_add_u32 v11, 83968, v4
    v_lshrrev_b32 v4, 2, v4
    v_mul_u32_u24 v12, 176, v4
    v_add_u32 v12, 84992, v12
    ds_write_b32 v11, v12
    v_mov_b32 v10, 2
    v_mov_b32 v55, 4
    v_mov_b32 v232, 83968
    v_cmp_le_u32 vcc, 245, v4
    s_nop 0
    s_mov_b64 s[60:61], vcc
    s_mov_b32 s43, 35584
    v_mul_lo_u32 v4, v4, s43
    v_lshrrev_b32 v11, 3, v1
    s_lshl_b32 s41, s13, 3
    v_add_u32 v11, s41, v11
    v_mul_u32_u24 v5, 260, v11
    v_add_u32 v5, 66048, v5
    v_add_u32 v6, 8320, v5
    v_and_b32 v12, 7, v1
    v_lshlrev_b32 v12, 4, v12
    v_lshl_add_u32 v7, v11, 7, v12
    s_lshl_b32 s41, s64, 6
    v_add_lshl_u32 v9, s41, v11, 1
    v_mov_b32 v17, v12
    v_mov_b32 v19, v12
    v_mov_b32 v21, v12
    v_mov_b32 v23, v12
    v_mov_b32 v24, 0
    v_mov_b32 v25, 0
    v_mov_b32 v26, 0
    v_mov_b32 v27, 0
    s_movk_i32 s42, 0x1000
    s_mov_b32 s65, 0x0c060c02
    s_movk_i32 s68, 0x3fc
    s_waitcnt vmcnt(0) lgkmcnt(0)
    s_barrier
    s_and_b32 s41, s14, s67
    s_add_u32 m0, s41, s15
    s_nop 0
    buffer_load_dwordx4 v2, s[16:19], s14 offen lds
    s_add_u32 s14, s14, 0x1000
    s_and_b32 s41, s14, s67
    s_add_u32 m0, s41, s15
    s_nop 0
    buffer_load_dwordx4 v2, s[16:19], s14 offen lds
    s_add_u32 s14, s14, 0x1000
    s_and_b32 s41, s14, s67
    s_add_u32 m0, s41, s15
    s_nop 0
    buffer_load_dwordx4 v2, s[16:19], s14 offen lds
    s_add_u32 s14, s14, 0x1000
    s_and_b32 s41, s14, s67
    s_add_u32 m0, s41, s15
    s_nop 0
    buffer_load_dwordx4 v2, s[16:19], s14 offen lds
    s_add_u32 s14, s14, 0x1000
    s_and_b32 s41, s14, s67
    s_add_u32 m0, s41, s15
    s_nop 0
    buffer_load_dwordx4 v2, s[16:19], s14 offen lds
    s_add_u32 s14, s14, 0x1000
    s_and_b32 s41, s14, s67
    s_add_u32 m0, s41, s15
    s_nop 0
    buffer_load_dwordx4 v2, s[16:19], s14 offen lds
    s_add_u32 s14, s14, 0x1000
    s_and_b32 s41, s14, s67
    s_add_u32 m0, s41, s15
    s_nop 0
    buffer_load_dwordx4 v2, s[16:19], s14 offen lds
    s_add_u32 s14, s14, 0x1000
    s_and_b32 s41, s14, s67
    s_add_u32 m0, s41, s15
    s_nop 0
    buffer_load_dwordx4 v2, s[16:19], s14 offen lds
    s_add_u32 s14, s14, 0x1000
    v_add_u32 v216, 0, v2
    buffer_load_dwordx4 v[184:187], v216, s[20:23], 0 offen
    v_add_u32 v217, 4096, v2
    buffer_load_dwordx4 v[188:191], v217, s[20:23], 0 offen
    v_add_u32 v218, 8192, v2
    buffer_load_dwordx4 v[192:195], v218, s[20:23], 0 offen
    v_add_u32 v219, 12288, v2
    buffer_load_dwordx4 v[196:199], v219, s[20:23], 0 offen
    buffer_load_dwordx4 v[200:203], v216, s[24:27], 0 offen
    buffer_load_dwordx4 v[204:207], v217, s[24:27], 0 offen
    buffer_load_dwordx4 v[208:211], v218, s[24:27], 0 offen
    buffer_load_dwordx4 v[212:215], v219, s[24:27], 0 offen
    buffer_load_ushort v8, v9, s[32:35], 0 offen
    buffer_load_ushort v9, v9, s[32:35], 0 offen offset:64
    s_waitcnt vmcnt(16)
    s_barrier
    s_and_b32 s41, s14, s67
    s_add_u32 m0, s41, s15
    s_nop 0
    buffer_load_dwordx4 v2, s[16:19], s14 offen lds
    s_add_u32 s14, s14, 0x1000
    s_and_b32 s41, s14, s67
    s_add_u32 m0, s41, s15
    s_nop 0
    buffer_load_dwordx4 v2, s[16:19], s14 offen lds
    s_add_u32 s14, s14, 0x1000
    s_and_b32 s41, s14, s67
    s_add_u32 m0, s41, s15
    s_nop 0
    buffer_load_dwordx4 v2, s[16:19], s14 offen lds
    s_add_u32 s14, s14, 0x1000
    s_and_b32 s41, s14, s67
    s_add_u32 m0, s41, s15
    s_nop 0
    buffer_load_dwordx4 v2, s[16:19], s14 offen lds
    s_add_u32 s14, s14, 0x1000
    s_waitcnt vmcnt(18)
    s_barrier
    s_and_b32 s41, s14, s67
    s_add_u32 m0, s41, s15
    s_nop 0
    buffer_load_dwordx4 v2, s[16:19], s14 offen lds
    s_add_u32 s14, s14, 0x1000
    s_and_b32 s41, s14, s67
    s_add_u32 m0, s41, s15
    s_nop 0
    buffer_load_dwordx4 v2, s[16:19], s14 offen lds
    s_add_u32 s14, s14, 0x1000
    s_and_b32 s41, s14, s67
    s_add_u32 m0, s41, s15
    s_nop 0
    buffer_load_dwordx4 v2, s[16:19], s14 offen lds
    s_add_u32 s14, s14, 0x1000
    s_and_b32 s41, s14, s67
    s_add_u32 m0, s41, s15
    s_nop 0
    buffer_load_dwordx4 v2, s[16:19], s14 offen lds
    s_add_u32 s14, s14, 0x1000
    s_waitcnt vmcnt(20)
    s_barrier
    s_and_b32 s41, s14, s67
    s_add_u32 m0, s41, s15
    s_nop 0
    buffer_load_dwordx4 v2, s[16:19], s14 offen lds
    s_add_u32 s14, s14, 0x1000
    s_and_b32 s41, s14, s67
    s_add_u32 m0, s41, s15
    s_nop 0
    buffer_load_dwordx4 v2, s[16:19], s14 offen lds
    s_add_u32 s14, s14, 0x1000
    s_sub_u32 s41, s44, 0
    s_cselect_b32 s41, 0, s41
    v_cmp_gt_u32 s[48:49], s41, v2
    s_waitcnt vmcnt(12)
    s_mov_b64 exec, s[48:49]
    v_lshrrev_b32 v216, 4, v184
    v_and_or_b32 v216, v216, s68, v232
    ds_add_rtn_u32 v216, v216, v55
    v_lshl_or_b32 v200, v184, 18, v200
    v_lshrrev_b32 v217, 4, v185
    v_and_or_b32 v217, v217, s68, v232
    ds_add_rtn_u32 v217, v217, v55
    v_lshl_or_b32 v201, v185, 18, v201
    v_lshrrev_b32 v218, 4, v186
    v_and_or_b32 v218, v218, s68, v232
    ds_add_rtn_u32 v218, v218, v55
    v_lshl_or_b32 v202, v186, 18, v202
    v_lshrrev_b32 v219, 4, v187
    v_and_or_b32 v219, v219, s68, v232
    ds_add_rtn_u32 v219, v219, v55
    v_lshl_or_b32 v203, v187, 18, v203
    s_waitcnt lgkmcnt(0)
    ds_write_b32 v216, v200
    ds_write_b32 v217, v201
    ds_write_b32 v218, v202
    ds_write_b32 v219, v203
    s_mov_b64 exec, -1
    s_sub_u32 s41, s44, 4096
    s_cselect_b32 s41, 0, s41
    v_cmp_gt_u32 s[48:49], s41, v2
    s_waitcnt vmcnt(12)
    s_mov_b64 exec, s[48:49]
    v_lshrrev_b32 v216, 4, v188
    v_and_or_b32 v216, v216, s68, v232
    ds_add_rtn_u32 v216, v216, v55
    v_lshl_or_b32 v204, v188, 18, v204
    v_lshrrev_b32 v217, 4, v189
    v_and_or_b32 v217, v217, s68, v232
    ds_add_rtn_u32 v217, v217, v55
    v_lshl_or_b32 v205, v189, 18, v205
    v_lshrrev_b32 v218, 4, v190
    v_and_or_b32 v218, v218, s68, v232
    ds_add_rtn_u32 v218, v218, v55
    v_lshl_or_b32 v206, v190, 18, v206
    v_lshrrev_b32 v219, 4, v191
    v_and_or_b32 v219, v219, s68, v232
    ds_add_rtn_u32 v219, v219, v55
    v_lshl_or_b32 v207, v191, 18, v207
    s_waitcnt lgkmcnt(0)
    ds_write_b32 v216, v204
    ds_write_b32 v217, v205
    ds_write_b32 v218, v206
    ds_write_b32 v219, v207
    s_mov_b64 exec, -1
    s_waitcnt lgkmcnt(0)
    s_waitcnt vmcnt(20)
    s_barrier
    s_and_b32 s41, s14, s67
    s_add_u32 m0, s41, s15
    s_nop 0
    buffer_load_dwordx4 v2, s[16:19], s14 offen lds
    s_add_u32 s14, s14, 0x1000
    s_and_b32 s41, s14, s67
    s_add_u32 m0, s41, s15
    s_nop 0
    buffer_load_dwordx4 v2, s[16:19], s14 offen lds
    s_add_u32 s14, s14, 0x1000
    s_sub_u32 s41, s44, 8192
    s_cselect_b32 s41, 0, s41
    v_cmp_gt_u32 s[48:49], s41, v2
    s_waitcnt vmcnt(14)
    s_mov_b64 exec, s[48:49]
    v_lshrrev_b32 v216, 4, v192
    v_and_or_b32 v216, v216, s68, v232
    ds_add_rtn_u32 v216, v216, v55
    v_lshl_or_b32 v208, v192, 18, v208
    v_lshrrev_b32 v217, 4, v193
    v_and_or_b32 v217, v217, s68, v232
    ds_add_rtn_u32 v217, v217, v55
    v_lshl_or_b32 v209, v193, 18, v209
    v_lshrrev_b32 v218, 4, v194
    v_and_or_b32 v218, v218, s68, v232
    ds_add_rtn_u32 v218, v218, v55
    v_lshl_or_b32 v210, v194, 18, v210
    v_lshrrev_b32 v219, 4, v195
    v_and_or_b32 v219, v219, s68, v232
    ds_add_rtn_u32 v219, v219, v55
    v_lshl_or_b32 v211, v195, 18, v211
    s_waitcnt lgkmcnt(0)
    ds_write_b32 v216, v208
    ds_write_b32 v217, v209
    ds_write_b32 v218, v210
    ds_write_b32 v219, v211
    s_mov_b64 exec, -1
    s_sub_u32 s41, s44, 12288
    s_cselect_b32 s41, 0, s41
    v_cmp_gt_u32 s[48:49], s41, v2
    s_waitcnt vmcnt(14)
    s_mov_b64 exec, s[48:49]
    v_lshrrev_b32 v216, 4, v196
    v_and_or_b32 v216, v216, s68, v232
    ds_add_rtn_u32 v216, v216, v55
    v_lshl_or_b32 v212, v196, 18, v212
    v_lshrrev_b32 v217, 4, v197
    v_and_or_b32 v217, v217, s68, v232
    ds_add_rtn_u32 v217, v217, v55
    v_lshl_or_b32 v213, v197, 18, v213
    v_lshrrev_b32 v218, 4, v198
    v_and_or_b32 v218, v218, s68, v232
    ds_add_rtn_u32 v218, v218, v55
    v_lshl_or_b32 v214, v198, 18, v214
    v_lshrrev_b32 v219, 4, v199
    v_and_or_b32 v219, v219, s68, v232
    ds_add_rtn_u32 v219, v219, v55
    v_lshl_or_b32 v215, v199, 18, v215
    s_waitcnt lgkmcnt(0)
    ds_write_b32 v216, v212
    ds_write_b32 v217, v213
    ds_write_b32 v218, v214
    ds_write_b32 v219, v215
    s_mov_b64 exec, -1
    s_waitcnt lgkmcnt(0)
    s_waitcnt vmcnt(10)
    s_barrier
    s_mul_i32 s41, s2, 35584
    s_add_u32 s41, s41, 0x1280000
    s_add_u32 s20, s4, s41
    s_addc_u32 s21, s5, 0
    s_mov_b32 s22, 0x8ac0
    s_mov_b32 s23, 0x00020000
    v_add_u32 v11, 84992, v2
    v_add_u32 v12, 1024, v2
    s_and_b32 s41, s14, s67
    s_add_u32 m0, s41, s15
    s_nop 0
    buffer_load_dwordx4 v2, s[16:19], s14 offen lds
    s_add_u32 s14, s14, 0x1000
    s_and_b32 s41, s14, s67
    s_add_u32 m0, s41, s15
    s_nop 0
    buffer_load_dwordx4 v2, s[16:19], s14 offen lds
    s_add_u32 s14, s14, 0x1000
    ds_read_b128 v[184:187], v11 offset:0
    ds_read_b128 v[188:191], v11 offset:4096
    ds_read_b128 v[192:195], v11 offset:8192
    ds_read_b128 v[196:199], v11 offset:12288
    ds_read_b128 v[200:203], v11 offset:16384
    s_waitcnt lgkmcnt(4)
    buffer_store_dwordx4 v[184:187], v12, s[20:23], 0 offen sc0 sc1
    v_add_u32 v12, 0x1000, v12
    s_waitcnt lgkmcnt(3)
    buffer_store_dwordx4 v[188:191], v12, s[20:23], 0 offen sc0 sc1
    v_add_u32 v12, 0x1000, v12
    s_waitcnt lgkmcnt(2)
    buffer_store_dwordx4 v[192:195], v12, s[20:23], 0 offen sc0 sc1
    v_add_u32 v12, 0x1000, v12
    s_waitcnt lgkmcnt(1)
    buffer_store_dwordx4 v[196:199], v12, s[20:23], 0 offen sc0 sc1
    v_add_u32 v12, 0x1000, v12
    s_waitcnt lgkmcnt(0)
    buffer_store_dwordx4 v[200:203], v12, s[20:23], 0 offen sc0 sc1
    v_add_u32 v12, 0x1000, v12
    s_waitcnt vmcnt(15)
    s_barrier
    s_and_b32 s41, s14, s67
    s_add_u32 m0, s41, s15
    s_nop 0
    buffer_load_dwordx4 v2, s[16:19], s14 offen lds
    s_add_u32 s14, s14, 0x1000
    s_and_b32 s41, s14, s67
    s_add_u32 m0, s41, s15
    s_nop 0
    buffer_load_dwordx4 v2, s[16:19], s14 offen lds
    s_add_u32 s14, s14, 0x1000
    ds_read_b128 v[184:187], v11 offset:20480
    ds_read_b128 v[188:191], v11 offset:24576
    ds_read_b128 v[192:195], v11 offset:28672
    ds_read_b128 v[196:199], v11 offset:32768
    s_waitcnt lgkmcnt(3)
    buffer_store_dwordx4 v[184:187], v12, s[20:23], 0 offen sc0 sc1
    v_add_u32 v12, 0x1000, v12
    s_waitcnt lgkmcnt(2)
    buffer_store_dwordx4 v[188:191], v12, s[20:23], 0 offen sc0 sc1
    v_add_u32 v12, 0x1000, v12
    s_waitcnt lgkmcnt(1)
    buffer_store_dwordx4 v[192:195], v12, s[20:23], 0 offen sc0 sc1
    v_add_u32 v12, 0x1000, v12
    s_waitcnt lgkmcnt(0)
    buffer_store_dwordx4 v[196:199], v12, s[20:23], 0 offen sc0 sc1
    v_add_u32 v12, 0x1000, v12
    s_waitcnt vmcnt(19)
    s_barrier
    s_and_b32 s41, s14, s67
    s_add_u32 m0, s41, s15
    s_nop 0
    buffer_load_dwordx4 v2, s[16:19], s14 offen lds
    s_add_u32 s14, s14, 0x1000
    s_and_b32 s41, s14, s67
    s_add_u32 m0, s41, s15
    s_nop 0
    buffer_load_dwordx4 v2, s[16:19], s14 offen lds
    s_add_u32 s14, s14, 0x1000
    s_waitcnt vmcnt(2)
    s_barrier
    s_and_b32 s41, s14, s67
    s_add_u32 m0, s41, s15
    s_nop 0
    buffer_load_dwordx4 v2, s[16:19], s14 offen lds
    s_add_u32 s14, s14, 0x1000
    s_and_b32 s41, s14, s67
    s_add_u32 m0, s41, s15
    s_nop 0
    buffer_load_dwordx4 v2, s[16:19], s14 offen lds
    s_add_u32 s14, s14, 0x1000
    s_cmp_lg_u32 s13, 0
    s_cbranch_scc1 K2_NODESC
    v_lshl_add_u32 v11, v1, 4, v232
    ds_read_b128 v[56:59], v11
    v_mul_u32_u24 v11, 704, v1
    s_waitcnt lgkmcnt(0)
    v_sub_u32 v56, v56, v11
    v_subrev_u32 v56, 84992, v56
    v_sub_u32 v57, v57, v11
    v_subrev_u32 v57, 85168, v57
    v_sub_u32 v58, v58, v11
    v_subrev_u32 v58, 85344, v58
    v_sub_u32 v59, v59, v11
    v_subrev_u32 v59, 85520, v59
    v_max3_u32 v11, v56, v57, v58
    v_max_u32 v11, v11, v59
    v_cmp_lt_u32 vcc, 176, v11
    s_nop 0
    s_cmp_lg_u64 vcc, 0
    s_cselect_b32 s41, 0xffff, 0
    s_or_b32 s41, s41, 0x80000000
    v_or_b32 v56, s41, v56
    v_or_b32 v57, s41, v57
    v_or_b32 v58, s41, v58
    v_or_b32 v59, s41, v59
    buffer_store_dwordx4 v[56:59], v2, s[20:23], 0 offen sc0 sc1
K2_NODESC:
    s_add_u32 s20, s4, 0x1280000
    s_addc_u32 s21, s5, 0
    s_mov_b32 s22, 0x850700
    s_mov_b32 s23, 0x00020000
    s_add_u32 s24, s4, 0x320000
    s_addc_u32 s25, s5, 0
    s_or_b32 s25, s25, 0x800000
    s_mov_b32 s26, 0x30d4
    s_mov_b32 s27, 0x00020000
    s_waitcnt vmcnt(19)
    s_barrier
    s_mov_b32 s12, 18
    s_mov_b32 s70, 19
    s_cmp_ge_u32 s64, 196
    s_cbranch_scc1 K2_IDLE
    s_lshl_b32 s43, s64, 2
    s_movk_i32 s38, 4000
    s_mov_b64 s[62:63], -1
    buffer_load_dword v3, v4, s[20:23], s43 offen sc0 sc1
    s_and_b32 s41, s14, s67
    s_add_u32 m0, s41, s15
    s_nop 0
    buffer_load_dwordx4 v2, s[16:19], s14 offen lds
    s_add_u32 s14, s14, 0x1000
    s_and_b32 s41, s14, s67
    s_add_u32 m0, s41, s15
    s_nop 0
    buffer_load_dwordx4 v2, s[16:19], s14 offen lds
    s_add_u32 s14, s14, 0x1000
    s_cmp_eq_u32 s70, -1
    s_cbranch_scc1 K2_PL0
    s_waitcnt vmcnt(10)
    s_barrier
    s_add_u32 s70, s70, 2
    s_cmp_ge_u32 s70, s11
    s_cselect_b32 s70, -1, s70
    s_cselect_b32 s67, 0, s67
    s_cselect_b32 s15, s66, s15
K2_PL0:
    s_add_u32 s12, s12, 2
K2_PL:
    s_waitcnt vmcnt(2)
    v_cmp_gt_i32 vcc, 0, v3
    s_nop 0
    s_or_b64 vcc, vcc, s[60:61]
    s_cmp_eq_u64 vcc, -1
    s_cbranch_scc1 K2_PL2
    s_sub_u32 s38, s38, 1
    s_cbranch_scc1 K2_PL3
    buffer_load_dword v3, v4, s[20:23], s43 offen sc0 sc1
    s_and_b32 s41, s14, s67
    s_add_u32 m0, s41, s15
    s_nop 0
    buffer_load_dwordx4 v2, s[16:19], s14 offen lds
    s_add_u32 s14, s14, 0x1000
    s_and_b32 s41, s14, s67
    s_add_u32 m0, s41, s15
    s_nop 0
    buffer_load_dwordx4 v2, s[16:19], s14 offen lds
    s_add_u32 s14, s14, 0x1000
    s_cmp_eq_u32 s70, -1
    s_cbranch_scc1 K2_PL1
    s_waitcnt vmcnt(10)
    s_barrier
    s_add_u32 s70, s70, 2
    s_cmp_ge_u32 s70, s11
    s_cselect_b32 s70, -1, s70
    s_cselect_b32 s67, 0, s67
    s_cselect_b32 s15, s66, s15
K2_PL1:
    s_add_u32 s12, s12, 2
    s_branch K2_PL
K2_PL3:
    ds_write_b32 v53, v53 offset:256
    s_branch K2_FILED
K2_PL2:
    s_and_b32 s41, s14, s67
    s_add_u32 m0, s41, s15
    s_nop 0
    buffer_load_dwordx4 v2, s[16:19], s14 offen lds
    s_add_u32 s14, s14, 0x1000
    s_and_b32 s41, s14, s67
    s_add_u32 m0, s41, s15
    s_nop 0
    buffer_load_dwordx4 v2, s[16:19], s14 offen lds
    s_add_u32 s14, s14, 0x1000
    s_mul_i32 s43, s64, 176
    v_bfe_u32 v3, v3, 2, 14
    v_cmp_lt_u32 vcc, 44, v3
    s_nop 0
    s_and_saveexec_b64 s[48:49], vcc
    ds_write_b32 v53, v53 offset:256
    v_mov_b32 v3, 0
    s_mov_b64 exec, -1
    buffer_load_dwordx4 v[56:59], v4, s[20:23], s43 offen offset:1024 sc0 sc1
    buffer_load_dwordx4 v[60:63], v4, s[20:23], s43 offen offset:1040 sc0 sc1
    s_mov_b64 exec, -1
    s_cmp_eq_u32 s70, -1
    s_cbranch_scc1 K2_SG2
    s_waitcnt vmcnt(12)
    s_barrier
    s_add_u32 s70, s70, 2
    s_cmp_ge_u32 s70, s11
    s_cselect_b32 s70, -1, s70
    s_cselect_b32 s67, 0, s67
    s_cselect_b32 s15, s66, s15
K2_SG2:
    s_add_u32 s12, s12, 2
    s_and_b32 s41, s14, s67
    s_add_u32 m0, s41, s15
    s_nop 0
    buffer_load_dwordx4 v2, s[16:19], s14 offen lds
    s_add_u32 s14, s14, 0x1000
    s_and_b32 s41, s14, s67
    s_add_u32 m0, s41, s15
    s_nop 0
    buffer_load_dwordx4 v2, s[16:19], s14 offen lds
    s_add_u32 s14, s14, 0x1000
    v_cmp_lt_u32 vcc, 8, v3
    s_nop 0
    s_or_b64 exec, vcc, 1
    buffer_load_dwordx4 v[64:67], v4, s[20:23], s43 offen offset:1056 sc0 sc1
    v_cmp_lt_u32 vcc, 12, v3
    s_nop 0
    s_or_b64 exec, vcc, 1
    buffer_load_dwordx4 v[68:71], v4, s[20:23], s43 offen offset:1072 sc0 sc1
    s_mov_b64 exec, -1
    s_cmp_eq_u32 s70, -1
    s_cbranch_scc1 K2_SG4
    s_waitcnt vmcnt(14)
    s_barrier
    s_add_u32 s70, s70, 2
    s_cmp_ge_u32 s70, s11
    s_cselect_b32 s70, -1, s70
    s_cselect_b32 s67, 0, s67
    s_cselect_b32 s15, s66, s15
K2_SG4:
    s_add_u32 s12, s12, 2
    s_and_b32 s41, s14, s67
    s_add_u32 m0, s41, s15
    s_nop 0
    buffer_load_dwordx4 v2, s[16:19], s14 offen lds
    s_add_u32 s14, s14, 0x1000
    s_and_b32 s41, s14, s67
    s_add_u32 m0, s41, s15
    s_nop 0
    buffer_load_dwordx4 v2, s[16:19], s14 offen lds
    s_add_u32 s14, s14, 0x1000
    v_cmp_lt_u32 vcc, 16, v3
    s_nop 0
    s_or_b64 exec, vcc, 1
    buffer_load_dwordx4 v[72:75], v4, s[20:23], s43 offen offset:1088 sc0 sc1
    v_cmp_lt_u32 vcc, 20, v3
    s_nop 0
    s_or_b64 exec, vcc, 1
    buffer_load_dwordx4 v[76:79], v4, s[20:23], s43 offen offset:1104 sc0 sc1
    s_mov_b64 exec, -1
    s_cmp_eq_u32 s70, -1
    s_cbranch_scc1 K2_SG6
    s_waitcnt vmcnt(16)
    s_barrier
    s_add_u32 s70, s70, 2
    s_cmp_ge_u32 s70, s11
    s_cselect_b32 s70, -1, s70
    s_cselect_b32 s67, 0, s67
    s_cselect_b32 s15, s66, s15
K2_SG6:
    s_add_u32 s12, s12, 2
    s_and_b32 s41, s14, s67
    s_add_u32 m0, s41, s15
    s_nop 0
    buffer_load_dwordx4 v2, s[16:19], s14 offen lds
    s_add_u32 s14, s14, 0x1000
    s_and_b32 s41, s14, s67
    s_add_u32 m0, s41, s15
    s_nop 0
    buffer_load_dwordx4 v2, s[16:19], s14 offen lds
    s_add_u32 s14, s14, 0x1000
    v_cmp_lt_u32 vcc, 24, v3
    s_nop 0
    s_or_b64 exec, vcc, 1
    buffer_load_dwordx4 v[80:83], v4, s[20:23], s43 offen offset:1120 sc0 sc1
    v_cmp_lt_u32 vcc, 28, v3
    s_nop 0
    s_or_b64 exec, vcc, 1
    buffer_load_dwordx4 v[84:87], v4, s[20:23], s43 offen offset:1136 sc0 sc1
    v_cmp_lt_u32 vcc, 32, v3
    s_nop 0
    s_or_b64 exec, vcc, 1
    buffer_load_dwordx4 v[88:91], v4, s[20:23], s43 offen offset:1152 sc0 sc1
    v_cmp_lt_u32 vcc, 36, v3
    s_nop 0
    s_or_b64 exec, vcc, 1
    buffer_load_dwordx4 v[92:95], v4, s[20:23], s43 offen offset:1168 sc0 sc1
    v_cmp_lt_u32 vcc, 40, v3
    s_nop 0
    s_or_b64 exec, vcc, 1
    buffer_load_dwordx4 v[96:99], v4, s[20:23], s43 offen offset:1184 sc0 sc1
    s_mov_b64 exec, -1
    s_cmp_eq_u32 s70, -1
    s_cbranch_scc1 K2_SG12
    s_waitcnt vmcnt(21)
    s_barrier
    s_add_u32 s70, s70, 2
    s_cmp_ge_u32 s70, s11
    s_cselect_b32 s70, -1, s70
    s_cselect_b32 s67, 0, s67
    s_cselect_b32 s15, s66, s15
K2_SG12:
    s_add_u32 s12, s12, 2
    s_and_b32 s41, s14, s67
    s_add_u32 m0, s41, s15
    s_nop 0
    buffer_load_dwordx4 v2, s[16:19], s14 offen lds
    s_add_u32 s14, s14, 0x1000
    s_and_b32 s41, s14, s67
    s_add_u32 m0, s41, s15
    s_nop 0
    buffer_load_dwordx4 v2, s[16:19], s14 offen lds
    s_add_u32 s14, s14, 0x1000
    s_waitcnt vmcnt(14)
    s_mov_b64 exec, s[62:63]
    v_cmpx_lt_u32 s[48:49], 0, v3
    s_cbranch_execz K2_INS0
    v_perm_b32 v44, v53, v56, s65
    ds_add_rtn_u32 v36, v44, v10
    v_cmpx_lt_u32 s[62:63], 1, v3
    v_perm_b32 v45, v53, v57, s65
    ds_add_rtn_u32 v37, v45, v10
    s_waitcnt lgkmcnt(0)
    ds_write_b16 v37, v57
    s_mov_b64 exec, s[48:49]
    ds_write_b16 v36, v56
    s_mov_b64 exec, s[62:63]
    v_cmpx_lt_u32 s[48:49], 2, v3
    s_cbranch_execz K2_INS0
    v_perm_b32 v44, v53, v58, s65
    ds_add_rtn_u32 v36, v44, v10
    v_cmpx_lt_u32 s[62:63], 3, v3
    v_perm_b32 v45, v53, v59, s65
    ds_add_rtn_u32 v37, v45, v10
    s_waitcnt lgkmcnt(0)
    ds_write_b16 v37, v59
    s_mov_b64 exec, s[48:49]
    ds_write_b16 v36, v58
    s_mov_b64 exec, s[62:63]
    v_cmpx_lt_u32 s[48:49], 4, v3
    s_cbranch_execz K2_INS0
    v_perm_b32 v44, v53, v60, s65
    ds_add_rtn_u32 v36, v44, v10
    v_cmpx_lt_u32 s[62:63], 5, v3
    v_perm_b32 v45, v53, v61, s65
    ds_add_rtn_u32 v37, v45, v10
    s_waitcnt lgkmcnt(0)
    ds_write_b16 v37, v61
    s_mov_b64 exec, s[48:49]
    ds_write_b16 v36, v60
    s_mov_b64 exec, s[62:63]
    v_cmpx_lt_u32 s[48:49], 6, v3
    s_cbranch_execz K2_INS0
    v_perm_b32 v44, v53, v62, s65
    ds_add_rtn_u32 v36, v44, v10
    v_cmpx_lt_u32 s[62:63], 7, v3
    v_perm_b32 v45, v53, v63, s65
    ds_add_rtn_u32 v37, v45, v10
    s_waitcnt lgkmcnt(0)
    ds_write_b16 v37, v63
    s_mov_b64 exec, s[48:49]
    ds_write_b16 v36, v62
    s_mov_b64 exec, s[62:63]
    v_cmpx_lt_u32 s[48:49], 8, v3
    s_cbranch_execz K2_INS0
    v_perm_b32 v44, v53, v64, s65
    ds_add_rtn_u32 v36, v44, v10
    v_cmpx_lt_u32 s[62:63], 9, v3
    v_perm_b32 v45, v53, v65, s65
    ds_add_rtn_u32 v37, v45, v10
    s_waitcnt lgkmcnt(0)
    ds_write_b16 v37, v65
    s_mov_b64 exec, s[48:49]
    ds_write_b16 v36, v64
    s_mov_b64 exec, s[62:63]
K2_INS0:
    s_cmp_eq_u64 exec, 0
    s_mov_b64 exec, -1
    s_cselect_b32 s39, 1, 0
    s_cmp_eq_u32 s70, -1
    s_cbranch_scc1 K2_IN0
    s_waitcnt vmcnt(21)
    s_barrier
    s_add_u32 s70, s70, 2
    s_cmp_ge_u32 s70, s11
    s_cselect_b32 s70, -1, s70
    s_cselect_b32 s67, 0, s67
    s_cselect_b32 s15, s66, s15
K2_IN0:
    s_add_u32 s12, s12, 2
    s_cmp_lg_u32 s39, 0
    s_cbranch_scc1 K2_FILED
    s_and_b32 s41, s14, s67
    s_add_u32 m0, s41, s15
    s_nop 0
    buffer_load_dwordx4 v2, s[16:19], s14 offen lds
    s_add_u32 s14, s14, 0x1000
    s_and_b32 s41, s14, s67
    s_add_u32 m0, s41, s15
    s_nop 0
    buffer_load_dwordx4 v2, s[16:19], s14 offen lds
    s_add_u32 s14, s14, 0x1000
    s_waitcnt vmcnt(12)
    s_mov_b64 exec, s[62:63]
    v_cmpx_lt_u32 s[48:49], 10, v3
    s_cbranch_execz K2_INS1
    v_perm_b32 v44, v53, v66, s65
    ds_add_rtn_u32 v36, v44, v10
    v_cmpx_lt_u32 s[62:63], 11, v3
    v_perm_b32 v45, v53, v67, s65
    ds_add_rtn_u32 v37, v45, v10
    s_waitcnt lgkmcnt(0)
    ds_write_b16 v37, v67
    s_mov_b64 exec, s[48:49]
    ds_write_b16 v36, v66
    s_mov_b64 exec, s[62:63]
    v_cmpx_lt_u32 s[48:49], 12, v3
    s_cbranch_execz K2_INS1
    v_perm_b32 v44, v53, v68, s65
    ds_add_rtn_u32 v36, v44, v10
    v_cmpx_lt_u32 s[62:63], 13, v3
    v_perm_b32 v45, v53, v69, s65
    ds_add_rtn_u32 v37, v45, v10
    s_waitcnt lgkmcnt(0)
    ds_write_b16 v37, v69
    s_mov_b64 exec, s[48:49]
    ds_write_b16 v36, v68
    s_mov_b64 exec, s[62:63]
    v_cmpx_lt_u32 s[48:49], 14, v3
    s_cbranch_execz K2_INS1
    v_perm_b32 v44, v53, v70, s65
    ds_add_rtn_u32 v36, v44, v10
    v_cmpx_lt_u32 s[62:63], 15, v3
    v_perm_b32 v45, v53, v71, s65
    ds_add_rtn_u32 v37, v45, v10
    s_waitcnt lgkmcnt(0)
    ds_write_b16 v37, v71
    s_mov_b64 exec, s[48:49]
    ds_write_b16 v36, v70
    s_mov_b64 exec, s[62:63]
    v_cmpx_lt_u32 s[48:49], 16, v3
    s_cbranch_execz K2_INS1
    v_perm_b32 v44, v53, v72, s65
    ds_add_rtn_u32 v36, v44, v10
    v_cmpx_lt_u32 s[62:63], 17, v3
    v_perm_b32 v45, v53, v73, s65
    ds_add_rtn_u32 v37, v45, v10
    s_waitcnt lgkmcnt(0)
    ds_write_b16 v37, v73
    s_mov_b64 exec, s[48:49]
    ds_write_b16 v36, v72
    s_mov_b64 exec, s[62:63]
    v_cmpx_lt_u32 s[48:49], 18, v3
    s_cbranch_execz K2_INS1
    v_perm_b32 v44, v53, v74, s65
    ds_add_rtn_u32 v36, v44, v10
    v_cmpx_lt_u32 s[62:63], 19, v3
    v_perm_b32 v45, v53, v75, s65
    ds_add_rtn_u32 v37, v45, v10
    s_waitcnt lgkmcnt(0)
    ds_write_b16 v37, v75
    s_mov_b64 exec, s[48:49]
    ds_write_b16 v36, v74
    s_mov_b64 exec, s[62:63]
K2_INS1:
    s_cmp_eq_u64 exec, 0
    s_mov_b64 exec, -1
    s_cselect_b32 s39, 1, 0
    s_cmp_eq_u32 s70, -1
    s_cbranch_scc1 K2_IN1
    s_waitcnt vmcnt(21)
    s_barrier
    s_add_u32 s70, s70, 2
    s_cmp_ge_u32 s70, s11
    s_cselect_b32 s70, -1, s70
    s_cselect_b32 s67, 0, s67
    s_cselect_b32 s15, s66, s15
K2_IN1:
    s_add_u32 s12, s12, 2
    s_cmp_lg_u32 s39, 0
    s_cbranch_scc1 K2_FILED
    s_and_b32 s41, s14, s67
    s_add_u32 m0, s41, s15
    s_nop 0
    buffer_load_dwordx4 v2, s[16:19], s14 offen lds
    s_add_u32 s14, s14, 0x1000
    s_and_b32 s41, s14, s67
    s_add_u32 m0, s41, s15
    s_nop 0
    buffer_load_dwordx4 v2, s[16:19], s14 offen lds
    s_add_u32 s14, s14, 0x1000
    s_waitcnt vmcnt(9)
    s_mov_b64 exec, s[62:63]
    v_cmpx_lt_u32 s[48:49], 20, v3
    s_cbranch_execz K2_INS2
    v_perm_b32 v44, v53, v76, s65
    ds_add_rtn_u32 v36, v44, v10
    v_cmpx_lt_u32 s[62:63], 21, v3
    v_perm_b32 v45, v53, v77, s65
    ds_add_rtn_u32 v37, v45, v10
    s_waitcnt lgkmcnt(0)
    ds_write_b16 v37, v77
    s_mov_b64 exec, s[48:49]
    ds_write_b16 v36, v76
    s_mov_b64 exec, s[62:63]
    v_cmpx_lt_u32 s[48:49], 22, v3
    s_cbranch_execz K2_INS2
    v_perm_b32 v44, v53, v78, s65
    ds_add_rtn_u32 v36, v44, v10
    v_cmpx_lt_u32 s[62:63], 23, v3
    v_perm_b32 v45, v53, v79, s65
    ds_add_rtn_u32 v37, v45, v10
    s_waitcnt lgkmcnt(0)
    ds_write_b16 v37, v79
    s_mov_b64 exec, s[48:49]
    ds_write_b16 v36, v78
    s_mov_b64 exec, s[62:63]
    v_cmpx_lt_u32 s[48:49], 24, v3
    s_cbranch_execz K2_INS2
    v_perm_b32 v44, v53, v80, s65
    ds_add_rtn_u32 v36, v44, v10
    v_cmpx_lt_u32 s[62:63], 25, v3
    v_perm_b32 v45, v53, v81, s65
    ds_add_rtn_u32 v37, v45, v10
    s_waitcnt lgkmcnt(0)
    ds_write_b16 v37, v81
    s_mov_b64 exec, s[48:49]
    ds_write_b16 v36, v80
    s_mov_b64 exec, s[62:63]
    v_cmpx_lt_u32 s[48:49], 26, v3
    s_cbranch_execz K2_INS2
    v_perm_b32 v44, v53, v82, s65
    ds_add_rtn_u32 v36, v44, v10
    v_cmpx_lt_u32 s[62:63], 27, v3
    v_perm_b32 v45, v53, v83, s65
    ds_add_rtn_u32 v37, v45, v10
    s_waitcnt lgkmcnt(0)
    ds_write_b16 v37, v83
    s_mov_b64 exec, s[48:49]
    ds_write_b16 v36, v82
    s_mov_b64 exec, s[62:63]
    v_cmpx_lt_u32 s[48:49], 28, v3
    s_cbranch_execz K2_INS2
    v_perm_b32 v44, v53, v84, s65
    ds_add_rtn_u32 v36, v44, v10
    v_cmpx_lt_u32 s[62:63], 29, v3
    v_perm_b32 v45, v53, v85, s65
    ds_add_rtn_u32 v37, v45, v10
    s_waitcnt lgkmcnt(0)
    ds_write_b16 v37, v85
    s_mov_b64 exec, s[48:49]
    ds_write_b16 v36, v84
    s_mov_b64 exec, s[62:63]
K2_INS2:
    s_cmp_eq_u64 exec, 0
    s_mov_b64 exec, -1
    s_cselect_b32 s39, 1, 0
    s_cmp_eq_u32 s70, -1
    s_cbranch_scc1 K2_IN2
    s_waitcnt vmcnt(19)
    s_barrier
    s_add_u32 s70, s70, 2
    s_cmp_ge_u32 s70, s11
    s_cselect_b32 s70, -1, s70
    s_cselect_b32 s67, 0, s67
    s_cselect_b32 s15, s66, s15
K2_IN2:
    s_add_u32 s12, s12, 2
    s_cmp_lg_u32 s39, 0
    s_cbranch_scc1 K2_FILED
    s_and_b32 s41, s14, s67
    s_add_u32 m0, s41, s15
    s_nop 0
    buffer_load_dwordx4 v2, s[16:19], s14 offen lds
    s_add_u32 s14, s14, 0x1000
    s_and_b32 s41, s14, s67
    s_add_u32 m0, s41, s15
    s_nop 0
    buffer_load_dwordx4 v2, s[16:19], s14 offen lds
    s_add_u32 s14, s14, 0x1000
    s_waitcnt vmcnt(9)
    s_mov_b64 exec, s[62:63]
    v_cmpx_lt_u32 s[48:49], 30, v3
    s_cbranch_execz K2_INS3
    v_perm_b32 v44, v53, v86, s65
    ds_add_rtn_u32 v36, v44, v10
    v_cmpx_lt_u32 s[62:63], 31, v3
    v_perm_b32 v45, v53, v87, s65
    ds_add_rtn_u32 v37, v45, v10
    s_waitcnt lgkmcnt(0)
    ds_write_b16 v37, v87
    s_mov_b64 exec, s[48:49]
    ds_write_b16 v36, v86
    s_mov_b64 exec, s[62:63]
    v_cmpx_lt_u32 s[48:49], 32, v3
    s_cbranch_execz K2_INS3
    v_perm_b32 v44, v53, v88, s65
    ds_add_rtn_u32 v36, v44, v10
    v_cmpx_lt_u32 s[62:63], 33, v3
    v_perm_b32 v45, v53, v89, s65
    ds_add_rtn_u32 v37, v45, v10
    s_waitcnt lgkmcnt(0)
    ds_write_b16 v37, v89
    s_mov_b64 exec, s[48:49]
    ds_write_b16 v36, v88
    s_mov_b64 exec, s[62:63]
    v_cmpx_lt_u32 s[48:49], 34, v3
    s_cbranch_execz K2_INS3
    v_perm_b32 v44, v53, v90, s65
    ds_add_rtn_u32 v36, v44, v10
    v_cmpx_lt_u32 s[62:63], 35, v3
    v_perm_b32 v45, v53, v91, s65
    ds_add_rtn_u32 v37, v45, v10
    s_waitcnt lgkmcnt(0)
    ds_write_b16 v37, v91
    s_mov_b64 exec, s[48:49]
    ds_write_b16 v36, v90
    s_mov_b64 exec, s[62:63]
    v_cmpx_lt_u32 s[48:49], 36, v3
    s_cbranch_execz K2_INS3
    v_perm_b32 v44, v53, v92, s65
    ds_add_rtn_u32 v36, v44, v10
    v_cmpx_lt_u32 s[62:63], 37, v3
    v_perm_b32 v45, v53, v93, s65
    ds_add_rtn_u32 v37, v45, v10
    s_waitcnt lgkmcnt(0)
    ds_write_b16 v37, v93
    s_mov_b64 exec, s[48:49]
    ds_write_b16 v36, v92
    s_mov_b64 exec, s[62:63]
    v_cmpx_lt_u32 s[48:49], 38, v3
    s_cbranch_execz K2_INS3
    v_perm_b32 v44, v53, v94, s65
    ds_add_rtn_u32 v36, v44, v10
    v_cmpx_lt_u32 s[62:63], 39, v3
    v_perm_b32 v45, v53, v95, s65
    ds_add_rtn_u32 v37, v45, v10
    s_waitcnt lgkmcnt(0)
    ds_write_b16 v37, v95
    s_mov_b64 exec, s[48:49]
    ds_write_b16 v36, v94
    s_mov_b64 exec, s[62:63]
K2_INS3:
    s_cmp_eq_u64 exec, 0
    s_mov_b64 exec, -1
    s_cselect_b32 s39, 1, 0
    s_cmp_eq_u32 s70, -1
    s_cbranch_scc1 K2_IN3
    s_waitcnt vmcnt(17)
    s_barrier
    s_add_u32 s70, s70, 2
    s_cmp_ge_u32 s70, s11
    s_cselect_b32 s70, -1, s70
    s_cselect_b32 s67, 0, s67
    s_cselect_b32 s15, s66, s15
K2_IN3:
    s_add_u32 s12, s12, 2
    s_cmp_lg_u32 s39, 0
    s_cbranch_scc1 K2_FILED
    s_and_b32 s41, s14, s67
    s_add_u32 m0, s41, s15
    s_nop 0
    buffer_load_dwordx4 v2, s[16:19], s14 offen lds
    s_add_u32 s14, s14, 0x1000
    s_and_b32 s41, s14, s67
    s_add_u32 m0, s41, s15
    s_nop 0
    buffer_load_dwordx4 v2, s[16:19], s14 offen lds
    s_add_u32 s14, s14, 0x1000
    s_waitcnt vmcnt(10)
    s_mov_b64 exec, s[62:63]
    v_cmpx_lt_u32 s[48:49], 40, v3
    s_cbranch_execz K2_INS4
    v_perm_b32 v44, v53, v96, s65
    ds_add_rtn_u32 v36, v44, v10
    v_cmpx_lt_u32 s[62:63], 41, v3
    v_perm_b32 v45, v53, v97, s65
    ds_add_rtn_u32 v37, v45, v10
    s_waitcnt lgkmcnt(0)
    ds_write_b16 v37, v97
    s_mov_b64 exec, s[48:49]
    ds_write_b16 v36, v96
    s_mov_b64 exec, s[62:63]
    v_cmpx_lt_u32 s[48:49], 42, v3
    s_cbranch_execz K2_INS4
    v_perm_b32 v44, v53, v98, s65
    ds_add_rtn_u32 v36, v44, v10
    v_cmpx_lt_u32 s[62:63], 43, v3
    v_perm_b32 v45, v53, v99, s65
    ds_add_rtn_u32 v37, v45, v10
    s_waitcnt lgkmcnt(0)
    ds_write_b16 v37, v99
    s_mov_b64 exec, s[48:49]
    ds_write_b16 v36, v98
    s_mov_b64 exec, s[62:63]
K2_INS4:
    s_cmp_eq_u64 exec, 0
    s_mov_b64 exec, -1
    s_cselect_b32 s39, 1, 0
    s_cmp_eq_u32 s70, -1
    s_cbranch_scc1 K2_IN4
    s_waitcnt vmcnt(15)
    s_barrier
    s_add_u32 s70, s70, 2
    s_cmp_ge_u32 s70, s11
    s_cselect_b32 s70, -1, s70
    s_cselect_b32 s67, 0, s67
    s_cselect_b32 s15, s66, s15
K2_IN4:
    s_add_u32 s12, s12, 2
K2_FILED:
    s_waitcnt lgkmcnt(0)
    s_mov_b64 exec, 1
    ds_add_u32 v53, v10 offset:268
    s_mov_b64 exec, -1
K2_W4:
    ds_read_b32 v11, v53 offset:268
    s_waitcnt lgkmcnt(0)
    v_readfirstlane_b32 s39, v11
    s_nop 0
    s_cmp_eq_u32 s39, 8
    s_cbranch_scc1 K2_CN
    s_and_b32 s41, s14, s67
    s_add_u32 m0, s41, s15
    s_nop 0
    buffer_load_dwordx4 v2, s[16:19], s14 offen lds
    s_add_u32 s14, s14, 0x1000
    s_and_b32 s41, s14, s67
    s_add_u32 m0, s41, s15
    s_nop 0
    buffer_load_dwordx4 v2, s[16:19], s14 offen lds
    s_add_u32 s14, s14, 0x1000
    s_cmp_eq_u32 s70, -1
    s_cbranch_scc1 K2_W41
    s_waitcnt vmcnt(10)
    s_barrier
    s_add_u32 s70, s70, 2
    s_cmp_ge_u32 s70, s11
    s_cselect_b32 s70, -1, s70
    s_cselect_b32 s67, 0, s67
    s_cselect_b32 s15, s66, s15
K2_W41:
    s_add_u32 s12, s12, 2
    s_branch K2_W4
K2_CN:
    s_and_b32 s41, s14, s67
    s_add_u32 m0, s41, s15
    s_nop 0
    buffer_load_dwordx4 v2, s[16:19], s14 offen lds
    s_add_u32 s14, s14, 0x1000
    s_and_b32 s41, s14, s67
    s_add_u32 m0, s41, s15
    s_nop 0
    buffer_load_dwordx4 v2, s[16:19], s14 offen lds
    s_add_u32 s14, s14, 0x1000
    ds_read_b32 v11, v52
    ds_read_b32 v15, v53 offset:256
    v_lshrrev_b32 v13, 3, v1
    s_lshl_b32 s41, s13, 5
    s_add_u32 s41, s41, 65536
    v_lshl_add_u32 v13, v13, 2, s41
    ds_read_b32 v14, v13
    ds_read_b32 v54, v13 offset:128
    ds_read_u16 v16, v5
    v_mul_u32_u24 v12, 260, v1
    v_lshlrev_b32 v8, 16, v8
    v_lshlrev_b32 v9, 16, v9
    v_mul_f32 v8, 0x3bc0c0c1, v8
    v_mul_f32 v9, 0x3bc0c0c1, v9
    s_waitcnt lgkmcnt(1)
    v_sub_u32 v11, v11, v12
    v_subrev_u32 v11, 66048, v11
    v_max_u32 v15, v15, v11
    v_cmp_lt_u32 vcc, 256, v15
    s_nop 0
    s_cmp_lg_u64 vcc, 0
    s_cselect_b32 s40, 1, 0
    v_sub_u32 v14, v5, v14
    v_sub_u32 v54, v6, v54
    v_mul_i32_i24 v14, 680, v14
    v_mul_i32_i24 v54, 680, v54
    v_mov_b32 v28, v14
    v_mov_b32 v29, v14
    v_mov_b32 v30, v14
    v_mov_b32 v31, v14
    v_mov_b32 v32, v14
    v_mov_b32 v33, v14
    v_mov_b32 v34, v14
    v_mov_b32 v35, v14
    v_max_u32_dpp v11, v11, v11 row_shr:1 row_mask:0xf bank_mask:0xf bound_ctrl:0
    s_nop 1
    v_max_u32_dpp v11, v11, v11 row_shr:2 row_mask:0xf bank_mask:0xf bound_ctrl:0
    s_nop 1
    v_max_u32_dpp v11, v11, v11 row_shr:4 row_mask:0xf bank_mask:0xf bound_ctrl:0
    s_lshl_b32 s41, s13, 3
    s_add_u32 s41, s41, 7
    s_add_u32 s43, s41, 32
    v_readlane_b32 s36, v11, s41
    v_readlane_b32 s37, v11, s43
    s_add_u32 s36, s36, 7
    s_lshr_b32 s36, s36, 3
    s_max_u32 s36, s36, 5
    s_add_u32 s37, s37, 7
    s_lshr_b32 s37, s37, 3
    s_max_u32 s37, s37, 1
    s_add_u32 s37, s37, s36
    s_mov_b32 s38, 5
    s_mov_b32 s39, 0
    s_cmp_lg_u32 s40, 0
    s_cbranch_scc1 K2_CX
    ds_read_u16 v18, v5 offset:2
    ds_read_u16 v20, v5 offset:4
    ds_read_u16 v22, v5 offset:6
    s_waitcnt lgkmcnt(3)
    buffer_load_dwordx4 v[104:107], v[16:17], s[24:27], 0 idxen offen
    s_waitcnt lgkmcnt(2)
    buffer_load_dwordx4 v[108:111], v[18:19], s[24:27], 0 idxen offen
    s_waitcnt lgkmcnt(1)
    buffer_load_dwordx4 v[112:115], v[20:21], s[24:27], 0 idxen offen
    s_waitcnt lgkmcnt(0)
    buffer_load_dwordx4 v[116:119], v[22:23], s[24:27], 0 idxen offen
    ds_read_u16 v16, v5 offset:8
    ds_read_u16 v18, v5 offset:10
    ds_read_u16 v20, v5 offset:12
    ds_read_u16 v22, v5 offset:14
    s_waitcnt lgkmcnt(3)
    buffer_load_dwordx4 v[120:123], v[16:17], s[24:27], 0 idxen offen
    s_waitcnt lgkmcnt(2)
    buffer_load_dwordx4 v[124:127], v[18:19], s[24:27], 0 idxen offen
    s_waitcnt lgkmcnt(1)
    buffer_load_dwordx4 v[128:131], v[20:21], s[24:27], 0 idxen offen
    s_waitcnt lgkmcnt(0)
    buffer_load_dwordx4 v[132:135], v[22:23], s[24:27], 0 idxen offen
    s_cmp_eq_u32 s70, -1
    s_cbranch_scc1 K2_PRE1
    s_waitcnt vmcnt(18)
    s_barrier
    s_add_u32 s70, s70, 2
    s_cmp_ge_u32 s70, s11
    s_cselect_b32 s70, -1, s70
    s_cselect_b32 s67, 0, s67
    s_cselect_b32 s15, s66, s15
K2_PRE1:
    s_add_u32 s12, s12, 2
    s_and_b32 s41, s14, s67
    s_add_u32 m0, s41, s15
    s_nop 0
    buffer_load_dwordx4 v2, s[16:19], s14 offen lds
    s_add_u32 s14, s14, 0x1000
    s_and_b32 s41, s14, s67
    s_add_u32 m0, s41, s15
    s_nop 0
    buffer_load_dwordx4 v2, s[16:19], s14 offen lds
    s_add_u32 s14, s14, 0x1000
    ds_read_u16 v16, v5 offset:16
    ds_read_u16 v18, v5 offset:18
    ds_read_u16 v20, v5 offset:20
    ds_read_u16 v22, v5 offset:22
    s_waitcnt lgkmcnt(3)
    buffer_load_dwordx4 v[136:139], v[16:17], s[24:27], 0 idxen offen
    s_waitcnt lgkmcnt(2)
    buffer_load_dwordx4 v[140:143], v[18:19], s[24:27], 0 idxen offen
    s_waitcnt lgkmcnt(1)
    buffer_load_dwordx4 v[144:147], v[20:21], s[24:27], 0 idxen offen
    s_waitcnt lgkmcnt(0)
    buffer_load_dwordx4 v[148:151], v[22:23], s[24:27], 0 idxen offen
    ds_read_u16 v16, v5 offset:24
    ds_read_u16 v18, v5 offset:26
    ds_read_u16 v20, v5 offset:28
    ds_read_u16 v22, v5 offset:30
    s_waitcnt lgkmcnt(3)
    buffer_load_dwordx4 v[152:155], v[16:17], s[24:27], 0 idxen offen
    s_waitcnt lgkmcnt(2)
    buffer_load_dwordx4 v[156:159], v[18:19], s[24:27], 0 idxen offen
    s_waitcnt lgkmcnt(1)
    buffer_load_dwordx4 v[160:163], v[20:21], s[24:27], 0 idxen offen
    s_waitcnt lgkmcnt(0)
    buffer_load_dwordx4 v[164:167], v[22:23], s[24:27], 0 idxen offen
    s_cmp_eq_u32 s70, -1
    s_cbranch_scc1 K2_PRE3
    s_waitcnt vmcnt(26)
    s_barrier
    s_add_u32 s70, s70, 2
    s_cmp_ge_u32 s70, s11
    s_cselect_b32 s70, -1, s70
    s_cselect_b32 s67, 0, s67
    s_cselect_b32 s15, s66, s15
K2_PRE3:
    s_add_u32 s12, s12, 2
    s_and_b32 s41, s14, s67
    s_add_u32 m0, s41, s15
    s_nop 0
    buffer_load_dwordx4 v2, s[16:19], s14 offen lds
    s_add_u32 s14, s14, 0x1000
    s_and_b32 s41, s14, s67
    s_add_u32 m0, s41, s15
    s_nop 0
    buffer_load_dwordx4 v2, s[16:19], s14 offen lds
    s_add_u32 s14, s14, 0x1000
    ds_read_u16 v16, v5 offset:32
    ds_read_u16 v18, v5 offset:34
    ds_read_u16 v20, v5 offset:36
    ds_read_u16 v22, v5 offset:38
    s_waitcnt lgkmcnt(3)
    buffer_load_dwordx4 v[168:171], v[16:17], s[24:27], 0 idxen offen
    s_waitcnt lgkmcnt(2)
    buffer_load_dwordx4 v[172:175], v[18:19], s[24:27], 0 idxen offen
    s_waitcnt lgkmcnt(1)
    buffer_load_dwordx4 v[176:179], v[20:21], s[24:27], 0 idxen offen
    s_waitcnt lgkmcnt(0)
    buffer_load_dwordx4 v[180:183], v[22:23], s[24:27], 0 idxen offen
    s_cmp_lg_u32 s38, s36
    s_cbranch_scc1 K2_PR1
    v_subrev_u32 v5, 40, v6
K2_PR1:
    ds_read_u16 v16, v5 offset:40
    s_branch K2_GP5
K2_CX:
    s_cmp_eq_u32 s70, -1
    s_cbranch_scc1 K2_CX1
    s_waitcnt vmcnt(10)
    s_barrier
    s_add_u32 s70, s70, 2
    s_cmp_ge_u32 s70, s11
    s_cselect_b32 s70, -1, s70
    s_cselect_b32 s67, 0, s67
    s_cselect_b32 s15, s66, s15
K2_CX1:
    s_add_u32 s12, s12, 2
    s_branch K2_IDLE
K2_G:
K2_GP0:
    s_waitcnt vmcnt(16) lgkmcnt(0)
    ds_read_u16 v18, v5 offset:2
    v_add3_u32 v24, v120, v124, v24
    buffer_load_dwordx4 v[104:107], v[16:17], s[24:27], 0 idxen offen
    s_and_b32 s41, s14, s67
    s_add_u32 m0, s41, s15
    v_add3_u32 v25, v121, v125, v25
    s_waitcnt lgkmcnt(0)
    ds_read_u16 v16, v5 offset:4
    v_add3_u32 v26, v122, v126, v26
    buffer_load_dwordx4 v[108:111], v[18:19], s[24:27], 0 idxen offen
    s_add_u32 s38, s38, 1
    v_add3_u32 v27, v123, v127, v27
    s_waitcnt lgkmcnt(0)
    ds_read_u16 v18, v5 offset:6
    v_add3_u32 v24, v128, v132, v24
    buffer_load_dwordx4 v[112:115], v[16:17], s[24:27], 0 idxen offen
    s_cmp_lg_u32 s38, s36
    v_add3_u32 v25, v129, v133, v25
    s_cbranch_scc1 K2_GA0
    v_subrev_u32 v5, 8, v6
K2_GA0:
    s_waitcnt lgkmcnt(0)
    ds_read_u16 v16, v5 offset:8
    v_add3_u32 v26, v130, v134, v26
    buffer_load_dwordx4 v[116:119], v[18:19], s[24:27], 0 idxen offen
    s_add_u32 s39, s39, 1
    v_add3_u32 v27, v131, v135, v27
    buffer_load_dwordx4 v2, s[16:19], s14 offen lds
    s_add_u32 s14, s14, 0x1000
    s_cmp_eq_u32 s39, s37
    s_cbranch_scc1 K2_GD0
    s_cmp_lg_u32 s39, s36
    s_cbranch_scc1 K2_GB0
    v_add_u32_sdwa v28, v24, v28 dst_sel:DWORD dst_unused:UNUSED_PAD src0_sel:WORD_0 src1_sel:DWORD
    v_add_u32_sdwa v29, v24, v29 dst_sel:DWORD dst_unused:UNUSED_PAD src0_sel:WORD_1 src1_sel:DWORD
    v_add_u32_sdwa v30, v25, v30 dst_sel:DWORD dst_unused:UNUSED_PAD src0_sel:WORD_0 src1_sel:DWORD
    v_add_u32_sdwa v31, v25, v31 dst_sel:DWORD dst_unused:UNUSED_PAD src0_sel:WORD_1 src1_sel:DWORD
    v_add_u32_sdwa v32, v26, v32 dst_sel:DWORD dst_unused:UNUSED_PAD src0_sel:WORD_0 src1_sel:DWORD
    v_add_u32_sdwa v33, v26, v33 dst_sel:DWORD dst_unused:UNUSED_PAD src0_sel:WORD_1 src1_sel:DWORD
    v_add_u32_sdwa v34, v27, v34 dst_sel:DWORD dst_unused:UNUSED_PAD src0_sel:WORD_0 src1_sel:DWORD
    v_add_u32_sdwa v35, v27, v35 dst_sel:DWORD dst_unused:UNUSED_PAD src0_sel:WORD_1 src1_sel:DWORD
    v_cvt_f32_i32 v28, v28
    v_cvt_f32_i32 v29, v29
    v_cvt_f32_i32 v30, v30
    v_cvt_f32_i32 v31, v31
    v_cvt_f32_i32 v32, v32
    v_cvt_f32_i32 v33, v33
    v_cvt_f32_i32 v34, v34
    v_cvt_f32_i32 v35, v35
    v_mul_f32 v28, v28, v8
    v_mul_f32 v29, v29, v8
    v_mul_f32 v30, v30, v8
    v_mul_f32 v31, v31, v8
    v_mul_f32 v32, v32, v8
    v_mul_f32 v33, v33, v8
    v_mul_f32 v34, v34, v8
    v_mul_f32 v35, v35, v8
    v_cvt_pk_bf16_f32 v12, v28, v29
    v_cvt_pk_bf16_f32 v13, v30, v31
    v_cvt_pk_bf16_f32 v14, v32, v33
    v_cvt_pk_bf16_f32 v15, v34, v35
    buffer_store_dwordx4 v[12:15], v7, s[28:31], 0 offen sc0 sc1
    v_mov_b32 v28, v54
    v_mov_b32 v29, v54
    v_mov_b32 v30, v54
    v_mov_b32 v31, v54
    v_mov_b32 v32, v54
    v_mov_b32 v33, v54
    v_mov_b32 v34, v54
    v_mov_b32 v35, v54
    v_mov_b32 v24, 0
    v_mov_b32 v25, 0
    v_mov_b32 v26, 0
    v_mov_b32 v27, 0
K2_GB0:
    v_add_u32_sdwa v28, v24, v28 dst_sel:DWORD dst_unused:UNUSED_PAD src0_sel:WORD_0 src1_sel:DWORD
    v_add_u32_sdwa v29, v24, v29 dst_sel:DWORD dst_unused:UNUSED_PAD src0_sel:WORD_1 src1_sel:DWORD
K2_GP1:
    s_waitcnt vmcnt(16) lgkmcnt(0)
    ds_read_u16 v18, v5 offset:10
    v_add3_u32 v24, v136, v140, 0
    buffer_load_dwordx4 v[120:123], v[16:17], s[24:27], 0 idxen offen
    s_and_b32 s41, s14, s67
    s_add_u32 m0, s41, s15
    v_add3_u32 v25, v137, v141, v25
    s_waitcnt lgkmcnt(0)
    ds_read_u16 v16, v5 offset:12
    v_add3_u32 v26, v138, v142, v26
    buffer_load_dwordx4 v[124:127], v[18:19], s[24:27], 0 idxen offen
    s_add_u32 s38, s38, 1
    v_add3_u32 v27, v139, v143, v27
    s_waitcnt lgkmcnt(0)
    ds_read_u16 v18, v5 offset:14
    v_add3_u32 v24, v144, v148, v24
    buffer_load_dwordx4 v[128:131], v[16:17], s[24:27], 0 idxen offen
    s_cmp_lg_u32 s38, s36
    v_add3_u32 v25, v145, v149, v25
    s_cbranch_scc1 K2_GA1
    v_subrev_u32 v5, 16, v6
K2_GA1:
    s_waitcnt lgkmcnt(0)
    ds_read_u16 v16, v5 offset:16
    v_add3_u32 v26, v146, v150, v26
    buffer_load_dwordx4 v[132:135], v[18:19], s[24:27], 0 idxen offen
    s_add_u32 s39, s39, 1
    v_add3_u32 v27, v147, v151, v27
    buffer_load_dwordx4 v2, s[16:19], s14 offen lds
    s_add_u32 s14, s14, 0x1000
    s_cmp_eq_u32 s39, s37
    s_cbranch_scc1 K2_GD1
    s_cmp_lg_u32 s39, s36
    s_cbranch_scc1 K2_GB1
    v_add_u32_sdwa v28, v24, v28 dst_sel:DWORD dst_unused:UNUSED_PAD src0_sel:WORD_0 src1_sel:DWORD
    v_add_u32_sdwa v29, v24, v29 dst_sel:DWORD dst_unused:UNUSED_PAD src0_sel:WORD_1 src1_sel:DWORD
    v_add_u32_sdwa v30, v25, v30 dst_sel:DWORD dst_unused:UNUSED_PAD src0_sel:WORD_0 src1_sel:DWORD
    v_add_u32_sdwa v31, v25, v31 dst_sel:DWORD dst_unused:UNUSED_PAD src0_sel:WORD_1 src1_sel:DWORD
    v_add_u32_sdwa v32, v26, v32 dst_sel:DWORD dst_unused:UNUSED_PAD src0_sel:WORD_0 src1_sel:DWORD
    v_add_u32_sdwa v33, v26, v33 dst_sel:DWORD dst_unused:UNUSED_PAD src0_sel:WORD_1 src1_sel:DWORD
    v_add_u32_sdwa v34, v27, v34 dst_sel:DWORD dst_unused:UNUSED_PAD src0_sel:WORD_0 src1_sel:DWORD
    v_add_u32_sdwa v35, v27, v35 dst_sel:DWORD dst_unused:UNUSED_PAD src0_sel:WORD_1 src1_sel:DWORD
    v_cvt_f32_i32 v28, v28
    v_cvt_f32_i32 v29, v29
    v_cvt_f32_i32 v30, v30
    v_cvt_f32_i32 v31, v31
    v_cvt_f32_i32 v32, v32
    v_cvt_f32_i32 v33, v33
    v_cvt_f32_i32 v34, v34
    v_cvt_f32_i32 v35, v35
    v_mul_f32 v28, v28, v8
    v_mul_f32 v29, v29, v8
    v_mul_f32 v30, v30, v8
    v_mul_f32 v31, v31, v8
    v_mul_f32 v32, v32, v8
    v_mul_f32 v33, v33, v8
    v_mul_f32 v34, v34, v8
    v_mul_f32 v35, v35, v8
    v_cvt_pk_bf16_f32 v12, v28, v29
    v_cvt_pk_bf16_f32 v13, v30, v31
    v_cvt_pk_bf16_f32 v14, v32, v33
    v_cvt_pk_bf16_f32 v15, v34, v35
    buffer_store_dwordx4 v[12:15], v7, s[28:31], 0 offen sc0 sc1
    v_mov_b32 v28, v54
    v_mov_b32 v29, v54
    v_mov_b32 v30, v54
    v_mov_b32 v31, v54
    v_mov_b32 v32, v54
    v_mov_b32 v33, v54
    v_mov_b32 v34, v54
    v_mov_b32 v35, v54
    v_mov_b32 v24, 0
    v_mov_b32 v25, 0
    v_mov_b32 v26, 0
    v_mov_b32 v27, 0
K2_GB1:
    v_add_u32_sdwa v30, v25, v30 dst_sel:DWORD dst_unused:UNUSED_PAD src0_sel:WORD_0 src1_sel:DWORD
    v_add_u32_sdwa v31, v25, v31 dst_sel:DWORD dst_unused:UNUSED_PAD src0_sel:WORD_1 src1_sel:DWORD
K2_GP2:
    s_waitcnt vmcnt(16) lgkmcnt(0)
    ds_read_u16 v18, v5 offset:18
    v_add3_u32 v24, v152, v156, v24
    buffer_load_dwordx4 v[136:139], v[16:17], s[24:27], 0 idxen offen
    v_add3_u32 v25, v153, v157, 0
    s_waitcnt lgkmcnt(0)
    ds_read_u16 v16, v5 offset:20
    v_add3_u32 v26, v154, v158, v26
    buffer_load_dwordx4 v[140:143], v[18:19], s[24:27], 0 idxen offen
    s_add_u32 s38, s38, 1
    v_add3_u32 v27, v155, v159, v27
    s_waitcnt lgkmcnt(0)
    ds_read_u16 v18, v5 offset:22
    v_add3_u32 v24, v160, v164, v24
    buffer_load_dwordx4 v[144:147], v[16:17], s[24:27], 0 idxen offen
    s_cmp_lg_u32 s38, s36
    v_add3_u32 v25, v161, v165, v25
    s_cbranch_scc1 K2_GA2
    v_subrev_u32 v5, 24, v6
K2_GA2:
    s_waitcnt lgkmcnt(0)
    ds_read_u16 v16, v5 offset:24
    v_add3_u32 v26, v162, v166, v26
    buffer_load_dwordx4 v[148:151], v[18:19], s[24:27], 0 idxen offen
    s_add_u32 s39, s39, 1
    v_add3_u32 v27, v163, v167, v27
    s_cmp_eq_u32 s39, s37
    s_cbranch_scc1 K2_GD2
    s_cmp_lg_u32 s39, s36
    s_cbranch_scc1 K2_GB2
    v_add_u32_sdwa v28, v24, v28 dst_sel:DWORD dst_unused:UNUSED_PAD src0_sel:WORD_0 src1_sel:DWORD
    v_add_u32_sdwa v29, v24, v29 dst_sel:DWORD dst_unused:UNUSED_PAD src0_sel:WORD_1 src1_sel:DWORD
    v_add_u32_sdwa v30, v25, v30 dst_sel:DWORD dst_unused:UNUSED_PAD src0_sel:WORD_0 src1_sel:DWORD
    v_add_u32_sdwa v31, v25, v31 dst_sel:DWORD dst_unused:UNUSED_PAD src0_sel:WORD_1 src1_sel:DWORD
    v_add_u32_sdwa v32, v26, v32 dst_sel:DWORD dst_unused:UNUSED_PAD src0_sel:WORD_0 src1_sel:DWORD
    v_add_u32_sdwa v33, v26, v33 dst_sel:DWORD dst_unused:UNUSED_PAD src0_sel:WORD_1 src1_sel:DWORD
    v_add_u32_sdwa v34, v27, v34 dst_sel:DWORD dst_unused:UNUSED_PAD src0_sel:WORD_0 src1_sel:DWORD
    v_add_u32_sdwa v35, v27, v35 dst_sel:DWORD dst_unused:UNUSED_PAD src0_sel:WORD_1 src1_sel:DWORD
    v_cvt_f32_i32 v28, v28
    v_cvt_f32_i32 v29, v29
    v_cvt_f32_i32 v30, v30
    v_cvt_f32_i32 v31, v31
    v_cvt_f32_i32 v32, v32
    v_cvt_f32_i32 v33, v33
    v_cvt_f32_i32 v34, v34
    v_cvt_f32_i32 v35, v35
    v_mul_f32 v28, v28, v8
    v_mul_f32 v29, v29, v8
    v_mul_f32 v30, v30, v8
    v_mul_f32 v31, v31, v8
    v_mul_f32 v32, v32, v8
    v_mul_f32 v33, v33, v8
    v_mul_f32 v34, v34, v8
    v_mul_f32 v35, v35, v8
    v_cvt_pk_bf16_f32 v12, v28, v29
    v_cvt_pk_bf16_f32 v13, v30, v31
    v_cvt_pk_bf16_f32 v14, v32, v33
    v_cvt_pk_bf16_f32 v15, v34, v35
    buffer_store_dwordx4 v[12:15], v7, s[28:31], 0 offen sc0 sc1
    v_mov_b32 v28, v54
    v_mov_b32 v29, v54
    v_mov_b32 v30, v54
    v_mov_b32 v31, v54
    v_mov_b32 v32, v54
    v_mov_b32 v33, v54
    v_mov_b32 v34, v54
    v_mov_b32 v35, v54
    v_mov_b32 v24, 0
    v_mov_b32 v25, 0
    v_mov_b32 v26, 0
    v_mov_b32 v27, 0
K2_GB2:
    v_add_u32_sdwa v32, v26, v32 dst_sel:DWORD dst_unused:UNUSED_PAD src0_sel:WORD_0 src1_sel:DWORD
    v_add_u32_sdwa v33, v26, v33 dst_sel:DWORD dst_unused:UNUSED_PAD src0_sel:WORD_1 src1_sel:DWORD
    s_cmp_eq_u32 s70, -1
    s_cbranch_scc1 K2_GC2
    s_barrier
    s_add_u32 s70, s70, 2
    s_cmp_ge_u32 s70, s11
    s_cselect_b32 s70, -1, s70
    s_cselect_b32 s67, 0, s67
    s_cselect_b32 s15, s66, s15
K2_GC2:
    s_add_u32 s12, s12, 2
K2_GP3:
    s_waitcnt vmcnt(16) lgkmcnt(0)
    ds_read_u16 v18, v5 offset:26
    v_add3_u32 v24, v168, v172, v24
    buffer_load_dwordx4 v[152:155], v[16:17], s[24:27], 0 idxen offen
    s_and_b32 s41, s14, s67
    s_add_u32 m0, s41, s15
    v_add3_u32 v25, v169, v173, v25
    s_waitcnt lgkmcnt(0)
    ds_read_u16 v16, v5 offset:28
    v_add3_u32 v26, v170, v174, 0
    buffer_load_dwordx4 v[156:159], v[18:19], s[24:27], 0 idxen offen
    s_add_u32 s38, s38, 1
    v_add3_u32 v27, v171, v175, v27
    s_waitcnt lgkmcnt(0)
    ds_read_u16 v18, v5 offset:30
    v_add3_u32 v24, v176, v180, v24
    buffer_load_dwordx4 v[160:163], v[16:17], s[24:27], 0 idxen offen
    s_cmp_lg_u32 s38, s36
    v_add3_u32 v25, v177, v181, v25
    s_cbranch_scc1 K2_GA3
    v_subrev_u32 v5, 32, v6
K2_GA3:
    s_waitcnt lgkmcnt(0)
    ds_read_u16 v16, v5 offset:32
    v_add3_u32 v26, v178, v182, v26
    buffer_load_dwordx4 v[164:167], v[18:19], s[24:27], 0 idxen offen
    s_add_u32 s39, s39, 1
    v_add3_u32 v27, v179, v183, v27
    buffer_load_dwordx4 v2, s[16:19], s14 offen lds
    s_add_u32 s14, s14, 0x1000
    s_cmp_eq_u32 s39, s37
    s_cbranch_scc1 K2_GD0
    s_cmp_lg_u32 s39, s36
    s_cbranch_scc1 K2_GB3
    v_add_u32_sdwa v28, v24, v28 dst_sel:DWORD dst_unused:UNUSED_PAD src0_sel:WORD_0 src1_sel:DWORD
    v_add_u32_sdwa v29, v24, v29 dst_sel:DWORD dst_unused:UNUSED_PAD src0_sel:WORD_1 src1_sel:DWORD
    v_add_u32_sdwa v30, v25, v30 dst_sel:DWORD dst_unused:UNUSED_PAD src0_sel:WORD_0 src1_sel:DWORD
    v_add_u32_sdwa v31, v25, v31 dst_sel:DWORD dst_unused:UNUSED_PAD src0_sel:WORD_1 src1_sel:DWORD
    v_add_u32_sdwa v32, v26, v32 dst_sel:DWORD dst_unused:UNUSED_PAD src0_sel:WORD_0 src1_sel:DWORD
    v_add_u32_sdwa v33, v26, v33 dst_sel:DWORD dst_unused:UNUSED_PAD src0_sel:WORD_1 src1_sel:DWORD
    v_add_u32_sdwa v34, v27, v34 dst_sel:DWORD dst_unused:UNUSED_PAD src0_sel:WORD_0 src1_sel:DWORD
    v_add_u32_sdwa v35, v27, v35 dst_sel:DWORD dst_unused:UNUSED_PAD src0_sel:WORD_1 src1_sel:DWORD
    v_cvt_f32_i32 v28, v28
    v_cvt_f32_i32 v29, v29
    v_cvt_f32_i32 v30, v30
    v_cvt_f32_i32 v31, v31
    v_cvt_f32_i32 v32, v32
    v_cvt_f32_i32 v33, v33
    v_cvt_f32_i32 v34, v34
    v_cvt_f32_i32 v35, v35
    v_mul_f32 v28, v28, v8
    v_mul_f32 v29, v29, v8
    v_mul_f32 v30, v30, v8
    v_mul_f32 v31, v31, v8
    v_mul_f32 v32, v32, v8
    v_mul_f32 v33, v33, v8
    v_mul_f32 v34, v34, v8
    v_mul_f32 v35, v35, v8
    v_cvt_pk_bf16_f32 v12, v28, v29
    v_cvt_pk_bf16_f32 v13, v30, v31
    v_cvt_pk_bf16_f32 v14, v32, v33
    v_cvt_pk_bf16_f32 v15, v34, v35
    buffer_store_dwordx4 v[12:15], v7, s[28:31], 0 offen sc0 sc1
    v_mov_b32 v28, v54
    v_mov_b32 v29, v54
    v_mov_b32 v30, v54
    v_mov_b32 v31, v54
    v_mov_b32 v32, v54
    v_mov_b32 v33, v54
    v_mov_b32 v34, v54
    v_mov_b32 v35, v54
    v_mov_b32 v24, 0
    v_mov_b32 v25, 0
    v_mov_b32 v26, 0
    v_mov_b32 v27, 0
K2_GB3:
    v_add_u32_sdwa v34, v27, v34 dst_sel:DWORD dst_unused:UNUSED_PAD src0_sel:WORD_0 src1_sel:DWORD
    v_add_u32_sdwa v35, v27, v35 dst_sel:DWORD dst_unused:UNUSED_PAD src0_sel:WORD_1 src1_sel:DWORD
K2_GP4:
    s_waitcnt vmcnt(16) lgkmcnt(0)
    ds_read_u16 v18, v5 offset:34
    v_add3_u32 v24, v184, v188, v24
    buffer_load_dwordx4 v[168:171], v[16:17], s[24:27], 0 idxen offen
    s_and_b32 s41, s14, s67
    s_add_u32 m0, s41, s15
    v_add3_u32 v25, v185, v189, v25
    s_waitcnt lgkmcnt(0)
    ds_read_u16 v16, v5 offset:36
    v_add3_u32 v26, v186, v190, v26
    buffer_load_dwordx4 v[172:175], v[18:19], s[24:27], 0 idxen offen
    s_add_u32 s38, s38, 1
    v_add3_u32 v27, v187, v191, 0
    s_waitcnt lgkmcnt(0)
    ds_read_u16 v18, v5 offset:38
    v_add3_u32 v24, v192, v196, v24
    buffer_load_dwordx4 v[176:179], v[16:17], s[24:27], 0 idxen offen
    s_cmp_lg_u32 s38, s36
    v_add3_u32 v25, v193, v197, v25
    s_cbranch_scc1 K2_GA4
    v_subrev_u32 v5, 40, v6
K2_GA4:
    s_waitcnt lgkmcnt(0)
    ds_read_u16 v16, v5 offset:40
    v_add3_u32 v26, v194, v198, v26
    buffer_load_dwordx4 v[180:183], v[18:19], s[24:27], 0 idxen offen
    s_add_u32 s39, s39, 1
    v_add3_u32 v27, v195, v199, v27
    buffer_load_dwordx4 v2, s[16:19], s14 offen lds
    s_add_u32 s14, s14, 0x1000
    s_cmp_eq_u32 s39, s37
    s_cbranch_scc1 K2_GD1
    s_cmp_lg_u32 s39, s36
    s_cbranch_scc1 K2_GB4
    v_add_u32_sdwa v28, v24, v28 dst_sel:DWORD dst_unused:UNUSED_PAD src0_sel:WORD_0 src1_sel:DWORD
    v_add_u32_sdwa v29, v24, v29 dst_sel:DWORD dst_unused:UNUSED_PAD src0_sel:WORD_1 src1_sel:DWORD
    v_add_u32_sdwa v30, v25, v30 dst_sel:DWORD dst_unused:UNUSED_PAD src0_sel:WORD_0 src1_sel:DWORD
    v_add_u32_sdwa v31, v25, v31 dst_sel:DWORD dst_unused:UNUSED_PAD src0_sel:WORD_1 src1_sel:DWORD
    v_add_u32_sdwa v32, v26, v32 dst_sel:DWORD dst_unused:UNUSED_PAD src0_sel:WORD_0 src1_sel:DWORD
    v_add_u32_sdwa v33, v26, v33 dst_sel:DWORD dst_unused:UNUSED_PAD src0_sel:WORD_1 src1_sel:DWORD
    v_add_u32_sdwa v34, v27, v34 dst_sel:DWORD dst_unused:UNUSED_PAD src0_sel:WORD_0 src1_sel:DWORD
    v_add_u32_sdwa v35, v27, v35 dst_sel:DWORD dst_unused:UNUSED_PAD src0_sel:WORD_1 src1_sel:DWORD
    v_cvt_f32_i32 v28, v28
    v_cvt_f32_i32 v29, v29
    v_cvt_f32_i32 v30, v30
    v_cvt_f32_i32 v31, v31
    v_cvt_f32_i32 v32, v32
    v_cvt_f32_i32 v33, v33
    v_cvt_f32_i32 v34, v34
    v_cvt_f32_i32 v35, v35
    v_mul_f32 v28, v28, v8
    v_mul_f32 v29, v29, v8
    v_mul_f32 v30, v30, v8
    v_mul_f32 v31, v31, v8
    v_mul_f32 v32, v32, v8
    v_mul_f32 v33, v33, v8
    v_mul_f32 v34, v34, v8
    v_mul_f32 v35, v35, v8
    v_cvt_pk_bf16_f32 v12, v28, v29
    v_cvt_pk_bf16_f32 v13, v30, v31
    v_cvt_pk_bf16_f32 v14, v32, v33
    v_cvt_pk_bf16_f32 v15, v34, v35
    buffer_store_dwordx4 v[12:15], v7, s[28:31], 0 offen sc0 sc1
    v_mov_b32 v28, v54
    v_mov_b32 v29, v54
    v_mov_b32 v30, v54
    v_mov_b32 v31, v54
    v_mov_b32 v32, v54
    v_mov_b32 v33, v54
    v_mov_b32 v34, v54
    v_mov_b32 v35, v54
    v_mov_b32 v24, 0
    v_mov_b32 v25, 0
    v_mov_b32 v26, 0
    v_mov_b32 v27, 0
K2_GB4:
K2_GP5:
    s_waitcnt vmcnt(16) lgkmcnt(0)
    ds_read_u16 v18, v5 offset:42
    v_add3_u32 v24, v104, v108, v24
    buffer_load_dwordx4 v[184:187], v[16:17], s[24:27], 0 idxen offen
    v_add3_u32 v25, v105, v109, v25
    s_waitcnt lgkmcnt(0)
    ds_read_u16 v16, v5 offset:44
    v_add3_u32 v26, v106, v110, v26
    buffer_load_dwordx4 v[188:191], v[18:19], s[24:27], 0 idxen offen
    s_add_u32 s38, s38, 1
    v_add3_u32 v27, v107, v111, v27
    s_waitcnt lgkmcnt(0)
    ds_read_u16 v18, v5 offset:46
    v_add3_u32 v24, v112, v116, v24
    buffer_load_dwordx4 v[192:195], v[16:17], s[24:27], 0 idxen offen
    s_cmp_lg_u32 s38, s36
    v_add3_u32 v25, v113, v117, v25
    v_add_u32 v5, 48, v5
    s_cbranch_scc1 K2_GA5
    v_subrev_u32 v5, 0, v6
K2_GA5:
    s_waitcnt lgkmcnt(0)
    ds_read_u16 v16, v5 offset:0
    v_add3_u32 v26, v114, v118, v26
    buffer_load_dwordx4 v[196:199], v[18:19], s[24:27], 0 idxen offen
    s_add_u32 s39, s39, 1
    v_add3_u32 v27, v115, v119, v27
    s_cmp_eq_u32 s39, s37
    s_cbranch_scc1 K2_GD2
    s_cmp_lg_u32 s39, s36
    s_cbranch_scc1 K2_GB5
    v_add_u32_sdwa v28, v24, v28 dst_sel:DWORD dst_unused:UNUSED_PAD src0_sel:WORD_0 src1_sel:DWORD
    v_add_u32_sdwa v29, v24, v29 dst_sel:DWORD dst_unused:UNUSED_PAD src0_sel:WORD_1 src1_sel:DWORD
    v_add_u32_sdwa v30, v25, v30 dst_sel:DWORD dst_unused:UNUSED_PAD src0_sel:WORD_0 src1_sel:DWORD
    v_add_u32_sdwa v31, v25, v31 dst_sel:DWORD dst_unused:UNUSED_PAD src0_sel:WORD_1 src1_sel:DWORD
    v_add_u32_sdwa v32, v26, v32 dst_sel:DWORD dst_unused:UNUSED_PAD src0_sel:WORD_0 src1_sel:DWORD
    v_add_u32_sdwa v33, v26, v33 dst_sel:DWORD dst_unused:UNUSED_PAD src0_sel:WORD_1 src1_sel:DWORD
    v_add_u32_sdwa v34, v27, v34 dst_sel:DWORD dst_unused:UNUSED_PAD src0_sel:WORD_0 src1_sel:DWORD
    v_add_u32_sdwa v35, v27, v35 dst_sel:DWORD dst_unused:UNUSED_PAD src0_sel:WORD_1 src1_sel:DWORD
    v_cvt_f32_i32 v28, v28
    v_cvt_f32_i32 v29, v29
    v_cvt_f32_i32 v30, v30
    v_cvt_f32_i32 v31, v31
    v_cvt_f32_i32 v32, v32
    v_cvt_f32_i32 v33, v33
    v_cvt_f32_i32 v34, v34
    v_cvt_f32_i32 v35, v35
    v_mul_f32 v28, v28, v8
    v_mul_f32 v29, v29, v8
    v_mul_f32 v30, v30, v8
    v_mul_f32 v31, v31, v8
    v_mul_f32 v32, v32, v8
    v_mul_f32 v33, v33, v8
    v_mul_f32 v34, v34, v8
    v_mul_f32 v35, v35, v8
    v_cvt_pk_bf16_f32 v12, v28, v29
    v_cvt_pk_bf16_f32 v13, v30, v31
    v_cvt_pk_bf16_f32 v14, v32, v33
    v_cvt_pk_bf16_f32 v15, v34, v35
    buffer_store_dwordx4 v[12:15], v7, s[28:31], 0 offen sc0 sc1
    v_mov_b32 v28, v54
    v_mov_b32 v29, v54
    v_mov_b32 v30, v54
    v_mov_b32 v31, v54
    v_mov_b32 v32, v54
    v_mov_b32 v33, v54
    v_mov_b32 v34, v54
    v_mov_b32 v35, v54
    v_mov_b32 v24, 0
    v_mov_b32 v25, 0
    v_mov_b32 v26, 0
    v_mov_b32 v27, 0
K2_GB5:
    s_cmp_eq_u32 s70, -1
    s_cbranch_scc1 K2_GC5
    s_barrier
    s_add_u32 s70, s70, 2
    s_cmp_ge_u32 s70, s11
    s_cselect_b32 s70, -1, s70
    s_cselect_b32 s67, 0, s67
    s_cselect_b32 s15, s66, s15
K2_GC5:
    s_add_u32 s12, s12, 2
    s_branch K2_G
K2_GD0:
    s_and_b32 s41, s14, s67
    s_add_u32 m0, s41, s15
    s_nop 0
    buffer_load_dwordx4 v2, s[16:19], s14 offen lds
    s_add_u32 s14, s14, 0x1000
K2_GD1:
K2_GD2:
    v_add_u32_sdwa v28, v24, v28 dst_sel:DWORD dst_unused:UNUSED_PAD src0_sel:WORD_0 src1_sel:DWORD
    v_add_u32_sdwa v29, v24, v29 dst_sel:DWORD dst_unused:UNUSED_PAD src0_sel:WORD_1 src1_sel:DWORD
    v_add_u32_sdwa v30, v25, v30 dst_sel:DWORD dst_unused:UNUSED_PAD src0_sel:WORD_0 src1_sel:DWORD
    v_add_u32_sdwa v31, v25, v31 dst_sel:DWORD dst_unused:UNUSED_PAD src0_sel:WORD_1 src1_sel:DWORD
    v_add_u32_sdwa v32, v26, v32 dst_sel:DWORD dst_unused:UNUSED_PAD src0_sel:WORD_0 src1_sel:DWORD
    v_add_u32_sdwa v33, v26, v33 dst_sel:DWORD dst_unused:UNUSED_PAD src0_sel:WORD_1 src1_sel:DWORD
    v_add_u32_sdwa v34, v27, v34 dst_sel:DWORD dst_unused:UNUSED_PAD src0_sel:WORD_0 src1_sel:DWORD
    v_add_u32_sdwa v35, v27, v35 dst_sel:DWORD dst_unused:UNUSED_PAD src0_sel:WORD_1 src1_sel:DWORD
    v_cvt_f32_i32 v28, v28
    v_cvt_f32_i32 v29, v29
    v_cvt_f32_i32 v30, v30
    v_cvt_f32_i32 v31, v31
    v_cvt_f32_i32 v32, v32
    v_cvt_f32_i32 v33, v33
    v_cvt_f32_i32 v34, v34
    v_cvt_f32_i32 v35, v35
    v_mul_f32 v28, v28, v9
    v_mul_f32 v29, v29, v9
    v_mul_f32 v30, v30, v9
    v_mul_f32 v31, v31, v9
    v_mul_f32 v32, v32, v9
    v_mul_f32 v33, v33, v9
    v_mul_f32 v34, v34, v9
    v_mul_f32 v35, v35, v9
    v_cvt_pk_bf16_f32 v12, v28, v29
    v_cvt_pk_bf16_f32 v13, v30, v31
    v_cvt_pk_bf16_f32 v14, v32, v33
    v_cvt_pk_bf16_f32 v15, v34, v35
    buffer_store_dwordx4 v[12:15], v7, s[28:31], s42 offen sc0 sc1
    s_cmp_eq_u32 s70, -1
    s_cbranch_scc1 K2_GCX
    s_waitcnt vmcnt(10)
    s_barrier
    s_add_u32 s70, s70, 2
    s_cmp_ge_u32 s70, s11
    s_cselect_b32 s70, -1, s70
    s_cselect_b32 s67, 0, s67
    s_cselect_b32 s15, s66, s15
K2_GCX:
    s_add_u32 s12, s12, 2
K2_IDLE:
    s_cmp_eq_u32 s70, -1
    s_cbranch_scc1 K2_AEND
    s_and_b32 s41, s14, s67
    s_add_u32 m0, s41, s15
    s_nop 0
    buffer_load_dwordx4 v2, s[16:19], s14 offen lds
    s_add_u32 s14, s14, 0x1000
    s_cmp_lg_u32 s12, s70
    s_cbranch_scc1 K2_IC
    s_waitcnt vmcnt(10)
    s_barrier
    s_add_u32 s70, s70, 2
    s_cmp_ge_u32 s70, s11
    s_cselect_b32 s70, -1, s70
    s_cselect_b32 s67, 0, s67
    s_cselect_b32 s15, s66, s15
K2_IC:
    s_add_u32 s12, s12, 1
    s_branch K2_IDLE
K2_AEND:
    v_mov_b32 v11, s40
    ds_write_b32 v53, v11 offset:260
    s_waitcnt lgkmcnt(0)
    s_cmp_eq_u32 s40, 0
    s_cbranch_scc1 K2_FIN
    s_waitcnt vmcnt(0)
    s_barrier
    v_add_u32 v11, 66048, v2
    v_mov_b32 v12, 0
    v_mov_b32 v13, 0
    v_mov_b32 v14, 0
    v_mov_b32 v15, 0
    ds_write_b128 v11, v[12:15] offset:0
    ds_write_b128 v11, v[12:15] offset:4096
    ds_write_b128 v11, v[12:15] offset:8192
    ds_write_b128 v11, v[12:15] offset:12288
    s_mov_b32 s20, s94
    s_mov_b32 s21, s95
    s_mov_b32 s22, 0x30d400
    s_mov_b32 s23, 0x00020000
    s_mov_b32 s32, s92
    s_mov_b32 s33, s93
    s_mov_b32 s34, 0x30d400
    s_mov_b32 s35, 0x00020000
    s_waitcnt lgkmcnt(0)
    s_barrier
    s_lshl_b32 s44, s13, 8
    v_lshlrev_b32 v39, 2, v1
    v_lshrrev_b32 v36, 3, v1
    v_and_b32 v37, 7, v1
    v_lshlrev_b32 v37, 5, v37
    v_add_u32 v37, 66048, v37
    s_add_u32 s45, s44, 83968
    v_lshl_add_u32 v40, v36, 2, s45
K2_S0:
    buffer_load_dword v44, v39, s[20:23], s44 offen
    buffer_load_dword v45, v39, s[32:35], s44 offen
    s_waitcnt vmcnt(0)
    v_lshrrev_b32 v46, 6, v44
    v_cmp_eq_u32 vcc, s64, v46
    s_nop 0
    s_bcnt1_i32_b64 s47, vcc
    s_cbranch_scc0 K2_S2
    v_mbcnt_lo_u32_b32 v46, vcc_lo, 0
    v_mbcnt_hi_u32_b32 v46, vcc_hi, v46
    v_lshl_add_u32 v46, v46, 2, s45
    v_lshl_or_b32 v44, v44, 18, v45
    s_mov_b64 exec, vcc
    ds_write_b32 v46, v44
    s_mov_b64 exec, -1
    v_mov_b32 v38, v36
    v_mov_b32 v41, v40
K2_S1:
    v_cmp_gt_u32 vcc, s47, v38
    s_nop 0
    s_and_saveexec_b64 s[48:49], vcc
    s_cbranch_execz K2_S2
    s_waitcnt lgkmcnt(0)
    ds_read_b32 v12, v41
    s_waitcnt lgkmcnt(0)
    v_and_b32 v16, 0xffff, v12
    buffer_load_dwordx4 v[104:107], v[16:17], s[24:27], 0 idxen offen
    v_bfe_u32 v11, v12, 18, 6
    v_lshl_add_u32 v11, v11, 8, v37
    s_waitcnt vmcnt(0)
    v_cvt_f32_u32_sdwa v28, v104 dst_sel:DWORD dst_unused:UNUSED_PAD src0_sel:WORD_0
    v_cvt_f32_u32_sdwa v29, v104 dst_sel:DWORD dst_unused:UNUSED_PAD src0_sel:WORD_1
    v_cvt_f32_u32_sdwa v30, v105 dst_sel:DWORD dst_unused:UNUSED_PAD src0_sel:WORD_0
    v_cvt_f32_u32_sdwa v31, v105 dst_sel:DWORD dst_unused:UNUSED_PAD src0_sel:WORD_1
    v_cvt_f32_u32_sdwa v32, v106 dst_sel:DWORD dst_unused:UNUSED_PAD src0_sel:WORD_0
    v_cvt_f32_u32_sdwa v33, v106 dst_sel:DWORD dst_unused:UNUSED_PAD src0_sel:WORD_1
    v_cvt_f32_u32_sdwa v34, v107 dst_sel:DWORD dst_unused:UNUSED_PAD src0_sel:WORD_0
    v_cvt_f32_u32_sdwa v35, v107 dst_sel:DWORD dst_unused:UNUSED_PAD src0_sel:WORD_1
    v_subrev_f32 v28, 0x44aa0000, v28
    v_subrev_f32 v29, 0x44aa0000, v29
    v_subrev_f32 v30, 0x44aa0000, v30
    v_subrev_f32 v31, 0x44aa0000, v31
    v_subrev_f32 v32, 0x44aa0000, v32
    v_subrev_f32 v33, 0x44aa0000, v33
    v_subrev_f32 v34, 0x44aa0000, v34
    v_subrev_f32 v35, 0x44aa0000, v35
    ds_add_f32 v11, v28 offset:0
    ds_add_f32 v11, v29 offset:4
    ds_add_f32 v11, v30 offset:8
    ds_add_f32 v11, v31 offset:12
    ds_add_f32 v11, v32 offset:16
    ds_add_f32 v11, v33 offset:20
    ds_add_f32 v11, v34 offset:24
    ds_add_f32 v11, v35 offset:28
    s_mov_b64 exec, -1
    v_add_u32 v38, 8, v38
    v_add_u32 v41, 32, v41
    s_branch K2_S1
K2_S2:
    s_mov_b64 exec, -1
    s_add_u32 s44, s44, 1024
    s_cmp_lt_u32 s44, 3200000
    s_cbranch_scc1 K2_S0
    s_waitcnt lgkmcnt(0)
    s_barrier
    v_lshlrev_b32 v11, 1, v7
    v_add_u32 v11, 66048, v11
    ds_read_b128 v[28:31], v11 offset:0
    ds_read_b128 v[32:35], v11 offset:16
    s_waitcnt lgkmcnt(0)
    v_mul_f32 v28, v28, v8
    v_mul_f32 v29, v29, v8
    v_mul_f32 v30, v30, v8
    v_mul_f32 v31, v31, v8
    v_mul_f32 v32, v32, v8
    v_mul_f32 v33, v33, v8
    v_mul_f32 v34, v34, v8
    v_mul_f32 v35, v35, v8
    v_cvt_pk_bf16_f32 v12, v28, v29
    v_cvt_pk_bf16_f32 v13, v30, v31
    v_cvt_pk_bf16_f32 v14, v32, v33
    v_cvt_pk_bf16_f32 v15, v34, v35
    buffer_store_dwordx4 v[12:15], v7, s[28:31], 0 offen sc0 sc1
    ds_read_b128 v[28:31], v11 offset:8192
    ds_read_b128 v[32:35], v11 offset:8208
    s_waitcnt lgkmcnt(0)
    v_mul_f32 v28, v28, v9
    v_mul_f32 v29, v29, v9
    v_mul_f32 v30, v30, v9
    v_mul_f32 v31, v31, v9
    v_mul_f32 v32, v32, v9
    v_mul_f32 v33, v33, v9
    v_mul_f32 v34, v34, v9
    v_mul_f32 v35, v35, v9
    v_cvt_pk_bf16_f32 v12, v28, v29
    v_cvt_pk_bf16_f32 v13, v30, v31
    v_cvt_pk_bf16_f32 v14, v32, v33
    v_cvt_pk_bf16_f32 v15, v34, v35
    buffer_store_dwordx4 v[12:15], v7, s[28:31], s42 offen sc0 sc1
    s_mov_b32 s40, 0
K2_FIN:
    s_setprio 0
    s_mov_b32 s44, s9
    s_mov_b32 s45, 0
    s_mov_b32 s46, 0
    s_mov_b32 s32, s100
    s_mov_b32 s33, s101
    s_mov_b32 s34, 0x186a00
    s_mov_b32 s35, 0x00020000
    s_mov_b32 s36, s96
    s_mov_b32 s37, s97
    s_mov_b32 s38, 0x186a00
    s_mov_b32 s39, 0x00020000
    s_add_u32 s24, s4, 0x640000
    s_addc_u32 s25, s5, 0
    s_mov_b32 s26, 0x4000
    s_mov_b32 s27, 0x00020000
K2_F0:
    s_mul_i32 s10, s3, 5
    s_add_u32 s10, s10, s44
    s_and_b32 s13, s10, 1
    s_bfe_u32 s12, s10, 0x10001
    s_lshl_b32 s12, s12, 4
    s_lshr_b32 s11, s10, 2
    s_cmp_lt_u32 s10, 32
    s_cselect_b32 s11, s11, 0x1000
    s_lshl_b32 s10, s8, 3
    s_add_u32 s10, s10, s11
    s_cmp_lt_u32 s10, 391
    s_cselect_b32 s47, 1, 0
    v_and_b32 v2, 15, v0
    v_or_b32 v4, s12, v2
    v_bfe_u32 v6, v0, 4, 2
    v_lshlrev_b32 v7, 7, v4
    v_lshl_add_u32 v7, v6, 4, v7
    s_lshl_b32 s11, s10, 12
    s_lshl_b32 s14, s13, 6
    v_add_u32 v8, s11, v7
    v_add_u32 v8, s14, v8
    v_lshlrev_b32 v5, 2, v4
    v_lshrrev_b32 v3, 1, v6
    v_lshlrev_b32 v3, 10, v3
    v_and_b32 v9, 1, v6
    v_lshl_or_b32 v3, v9, 9, v3
    v_lshl_add_u32 v9, v4, 4, v3
    v_and_b32 v10, 7, v2
    v_bfe_u32 v11, v2, 3, 1
    v_lshl_or_b32 v10, v11, 4, v10
    v_lshl_add_u32 v10, v10, 4, v3
    s_lshl_b32 s12, s10, 7
    s_lshl_b32 s14, s13, 12
    s_add_u32 s15, s14, 0x2000
    s_mov_b32 s13, s11
    s_cmp_eq_u32 s47, 0
    s_cbranch_scc1 K2_F1
    buffer_load_dwordx4 v[144:147], v8, s[32:35], 0 offen
    buffer_load_dwordx4 v[112:115], v10, s[24:27], s15 offen offset:0
    buffer_load_dwordx4 v[116:119], v10, s[24:27], s15 offen offset:2048
    buffer_load_dwordx4 v[120:123], v10, s[24:27], s15 offen offset:128
    buffer_load_dwordx4 v[124:127], v10, s[24:27], s15 offen offset:2176
    buffer_load_dwordx4 v[96:99], v10, s[24:27], s14 offen offset:0
    buffer_load_dwordx4 v[100:103], v10, s[24:27], s14 offen offset:2048
    buffer_load_dwordx4 v[104:107], v10, s[24:27], s14 offen offset:128
    buffer_load_dwordx4 v[108:111], v10, s[24:27], s14 offen offset:2176
    s_waitcnt vmcnt(9)
    s_branch K2_F2
K2_F1:
    s_waitcnt vmcnt(0)
K2_F2:
    s_cmp_lg_u32 s45, 0
    s_cbranch_scc1 K2_F5
    v_mov_b32 v12, 65536
    s_barrier
    s_cmp_ge_u32 s3, 4
    s_cbranch_scc1 K2_F4
    ds_read_b32 v12, v12 offset:260
    s_waitcnt lgkmcnt(0)
    v_readfirstlane_b32 s40, v12
    s_nop 0
    s_cmp_eq_u32 s40, 0
    s_cbranch_scc1 K2_F3
    s_barrier
    s_barrier
    s_barrier
K2_F3:
    s_cmp_lg_u32 s3, 0
    s_cbranch_scc1 K2_F4
    s_lshl_b32 s48, s8, 8
    s_add_u32 s48, s48, 0x644000
    s_lshl_b32 s49, 1, s9
    v_mov_b32 v12, s48
    v_mov_b32 v13, 1
    s_mov_b64 exec, 1
    global_atomic_add v14, v12, v13, s[4:5] sc0
    s_mov_b32 s50, 400
    s_waitcnt vmcnt(0)
    v_readfirstlane_b32 s48, v14
    s_nop 0
    s_and_b32 s51, s48, 7
    s_cmp_lg_u32 s51, 4
    s_cbranch_scc1 K2_POLL
    s_lshr_b32 s48, s48, 8
    s_or_b32 s49, s49, s48
    s_branch K2_HS
K2_POLL:
    global_load_dword v14, v12, s[4:5] sc1
    s_waitcnt vmcnt(0)
    v_readfirstlane_b32 s48, v14
    s_nop 0
    s_and_b32 s51, s48, 7
    s_cmp_eq_u32 s51, 5
    s_cbranch_scc1 K2_HS
    s_sub_u32 s50, s50, 1
    s_cbranch_scc0 K2_POLL
    s_lshl_b32 s51, s49, 8
    v_mov_b32 v13, s51
    global_atomic_or v14, v12, v13, s[4:5] sc0
    s_waitcnt vmcnt(0)
    v_readfirstlane_b32 s48, v14
    s_nop 0
    s_and_b32 s51, s48, 7
    s_cmp_eq_u32 s51, 5
    s_cselect_b32 s49, s49, 0
K2_HS:
    v_mov_b32 v12, 65536
    v_mov_b32 v13, s49
    ds_write_b32 v12, v13 offset:264
    s_mov_b64 exec, -1
    s_waitcnt lgkmcnt(0)
K2_F4:
    s_barrier
    v_mov_b32 v12, 65536
    ds_read_b32 v12, v12 offset:264
    s_lshl_b32 s49, 1, s9
    s_mov_b32 s45, 1
    s_waitcnt lgkmcnt(0)
    v_readfirstlane_b32 s46, v12
    s_nop 0
    s_cmp_eq_u32 s46, 0
    s_cbranch_scc1 K2_END
    s_andn2_b32 s46, s46, s49
K2_F5:
    s_cmp_eq_u32 s47, 0
    s_cbranch_scc1 K2_F6
    s_add_u32 s16, s4, 0x650000
    s_addc_u32 s17, s5, 0
    s_mov_b32 s18, 0x3d400
    s_mov_b32 s19, 0x00020000
    buffer_load_dword v152, v5, s[16:19], s12 offen sc0 sc1
    s_add_u32 s12, s12, 50176
    buffer_load_dword v153, v5, s[16:19], s12 offen sc0 sc1
    s_add_u32 s12, s12, 50176
    buffer_load_dword v154, v5, s[16:19], s12 offen sc0 sc1
    s_add_u32 s12, s12, 50176
    buffer_load_dword v155, v5, s[16:19], s12 offen sc0 sc1
    s_add_u32 s12, s12, 50176
    buffer_load_dword v156, v5, s[16:19], s12 offen sc0 sc1
    s_add_u32 s20, s4, 0xac0000
    s_addc_u32 s21, s5, 0
    s_mov_b32 s22, 0x7a8000
    s_mov_b32 s23, 0x00020000
    buffer_load_dwordx4 v[16:19], v9, s[20:23], s13 offen offset:0 sc0 sc1
    buffer_load_dwordx4 v[20:23], v9, s[20:23], s13 offen offset:2048 sc0 sc1
    s_add_u32 s13, s13, 1605632
    buffer_load_dwordx4 v[24:27], v9, s[20:23], s13 offen offset:0 sc0 sc1
    buffer_load_dwordx4 v[28:31], v9, s[20:23], s13 offen offset:2048 sc0 sc1
    s_add_u32 s13, s13, 1605632
    buffer_load_dwordx4 v[32:35], v9, s[20:23], s13 offen offset:0 sc0 sc1
    buffer_load_dwordx4 v[36:39], v9, s[20:23], s13 offen offset:2048 sc0 sc1
    s_add_u32 s13, s13, 1605632
    buffer_load_dwordx4 v[40:43], v9, s[20:23], s13 offen offset:0 sc0 sc1
    buffer_load_dwordx4 v[44:47], v9, s[20:23], s13 offen offset:2048 sc0 sc1
    s_add_u32 s13, s13, 1605632
    buffer_load_dwordx4 v[48:51], v9, s[20:23], s13 offen offset:0 sc0 sc1
    buffer_load_dwordx4 v[52:55], v9, s[20:23], s13 offen offset:2048 sc0 sc1
    s_add_u32 s28, s4, 0x4b0000
    s_addc_u32 s29, s5, 0
    s_mov_b32 s30, 0x188000
    s_mov_b32 s31, 0x00020000
    buffer_load_dwordx4 v[128:131], v7, s[28:31], s11 offen offset:0 sc0 sc1
    buffer_load_dwordx4 v[132:135], v7, s[28:31], s11 offen offset:64 sc0 sc1
    s_mov_b32 s40, 0x17800000
    s_mov_b32 s41, 0x7b800000
    s_waitcnt vmcnt(12)
    v_add_f32 v152, v152, v153
    v_add_f32 v154, v154, v155
    v_add_f32 v152, v152, v156
    v_add_f32 v152, v152, v154
    v_cmp_le_f32 vcc, s40, v152
    v_cmp_ge_f32 s[42:43], s41, v152
    s_nop 0
    s_and_b64 vcc, vcc, s[42:43]
    s_cmp_eq_u64 vcc, -1
    s_cbranch_scc0 K2_XEXACT
K2_GO:
    v_rcp_f32 v152, v152
    v_lshlrev_b32 v176, 16, v144
    v_and_b32 v177, 0xffff0000, v144
    v_lshlrev_b32 v178, 16, v145
    v_and_b32 v179, 0xffff0000, v145
    v_lshlrev_b32 v180, 16, v146
    v_and_b32 v181, 0xffff0000, v146
    v_lshlrev_b32 v182, 16, v147
    v_and_b32 v183, 0xffff0000, v147
    s_waitcnt vmcnt(10)
    v_mfma_f32_16x16x32_bf16 v[160:163], v[96:99], v[16:19], 0
    v_mfma_f32_16x16x32_bf16 v[164:167], v[104:107], v[16:19], 0
    v_mfma_f32_16x16x32_bf16 v[160:163], v[100:103], v[20:23], v[160:163]
    v_mfma_f32_16x16x32_bf16 v[164:167], v[108:111], v[20:23], v[164:167]
    s_waitcnt vmcnt(8)
    v_mfma_f32_16x16x32_bf16 v[160:163], v[96:99], v[24:27], v[160:163]
    v_mfma_f32_16x16x32_bf16 v[164:167], v[104:107], v[24:27], v[164:167]
    v_mfma_f32_16x16x32_bf16 v[160:163], v[100:103], v[28:31], v[160:163]
    v_mfma_f32_16x16x32_bf16 v[164:167], v[108:111], v[28:31], v[164:167]
    s_waitcnt vmcnt(6)
    v_mfma_f32_16x16x32_bf16 v[160:163], v[96:99], v[32:35], v[160:163]
    v_mfma_f32_16x16x32_bf16 v[164:167], v[104:107], v[32:35], v[164:167]
    v_mfma_f32_16x16x32_bf16 v[160:163], v[100:103], v[36:39], v[160:163]
    v_mfma_f32_16x16x32_bf16 v[164:167], v[108:111], v[36:39], v[164:167]
    s_waitcnt vmcnt(4)
    v_mfma_f32_16x16x32_bf16 v[160:163], v[96:99], v[40:43], v[160:163]
    v_mfma_f32_16x16x32_bf16 v[164:167], v[104:107], v[40:43], v[164:167]
    v_mfma_f32_16x16x32_bf16 v[160:163], v[100:103], v[44:47], v[160:163]
    v_mfma_f32_16x16x32_bf16 v[164:167], v[108:111], v[44:47], v[164:167]
    s_waitcnt vmcnt(2)
    v_mfma_f32_16x16x32_bf16 v[160:163], v[96:99], v[48:51], v[160:163]
    v_mfma_f32_16x16x32_bf16 v[164:167], v[104:107], v[48:51], v[164:167]
    v_mfma_f32_16x16x32_bf16 v[160:163], v[100:103], v[52:55], v[160:163]
    v_mfma_f32_16x16x32_bf16 v[164:167], v[108:111], v[52:55], v[164:167]
    s_waitcnt vmcnt(0)
    v_mfma_f32_16x16x32_bf16 v[176:179], v[112:115], v[128:131], v[176:179]
    v_mfma_f32_16x16x32_bf16 v[180:183], v[120:123], v[128:131], v[180:183]
    v_mfma_f32_16x16x32_bf16 v[176:179], v[116:119], v[132:135], v[176:179]
    v_mfma_f32_16x16x32_bf16 v[180:183], v[124:127], v[132:135], v[180:183]
    s_nop 6
    v_fmac_f32 v176, v160, v152
    v_fmac_f32 v177, v161, v152
    v_fmac_f32 v178, v162, v152
    v_fmac_f32 v179, v163, v152
    v_fmac_f32 v180, v164, v152
    v_fmac_f32 v181, v165, v152
    v_fmac_f32 v182, v166, v152
    v_fmac_f32 v183, v167, v152
    v_cvt_pk_bf16_f32 v144, v176, v177
    v_cvt_pk_bf16_f32 v145, v178, v179
    v_cvt_pk_bf16_f32 v146, v180, v181
    v_cvt_pk_bf16_f32 v147, v182, v183
    buffer_store_dwordx4 v[144:147], v8, s[36:39], 0 offen sc0 sc1
K2_F6:
    s_cmp_eq_u32 s46, 0
    s_cbranch_scc1 K2_END
    s_ff1_i32_b32 s44, s46
    s_bitset0_b32 s46, s44
    s_branch K2_F0
K2_XEXACT:
    s_waitcnt vmcnt(0)
    v_lshlrev_b32 v12, 2, v4
    v_add_u32 v12, 128, v12
    v_and_b32 v3, 63, v0
    v_lshrrev_b32 v6, 5, v3
    v_lshlrev_b32 v3, 4, v3
    v_and_b32 v4, 31, v0
    s_add_u32 s72, s4, 0x190000
    s_addc_u32 s73, s5, 0
    s_mov_b32 s74, 0x187000
    s_mov_b32 s75, 0x00020000
    s_mov_b32 s76, s4
    s_mov_b32 s77, s5
    s_mov_b32 s78, 0x187000
    s_mov_b32 s79, 0x00020000
    buffer_load_dwordx4 v[16:19], v3, s[72:75], s11 offen offset:0
    buffer_load_dwordx4 v[20:23], v3, s[72:75], s11 offen offset:1024
    buffer_load_dwordx4 v[24:27], v3, s[72:75], s11 offen offset:2048
    buffer_load_dwordx4 v[28:31], v3, s[72:75], s11 offen offset:3072
    s_lshl_b32 s52, s3, 12
    v_bfe_u32 v14, v4, 1, 1
    v_lshlrev_b32 v14, 2, v14
    v_bfe_u32 v15, v4, 2, 2
    v_or_b32 v14, v14, v15
    v_xor_b32 v14, v14, v6
    v_lshlrev_b32 v15, 7, v4
    v_add_u32 v15, s52, v15
    v_xor_b32 v228, 0, v14
    v_lshl_add_u32 v232, v228, 4, v15
    v_xor_b32 v228, 2, v14
    v_lshl_add_u32 v233, v228, 4, v15
    v_xor_b32 v228, 4, v14
    v_lshl_add_u32 v234, v228, 4, v15
    v_xor_b32 v228, 6, v14
    v_lshl_add_u32 v235, v228, 4, v15
    v_bfe_u32 v14, v0, 2, 2
    v_lshl_add_u32 v15, v6, 2, v14
    v_lshlrev_b32 v15, 7, v15
    v_and_b32 v228, 1, v0
    v_lshl_add_u32 v15, v228, 3, v15
    v_add_u32 v15, s52, v15
    v_bfe_u32 v228, v0, 4, 1
    v_lshlrev_b32 v228, 1, v228
    v_bfe_u32 v229, v0, 1, 1
    v_or_b32 v228, v228, v229
    v_lshrrev_b32 v14, 1, v14
    v_lshl_or_b32 v14, v14, 2, v6
    v_xor_b32 v14, v14, v228
    v_xor_b32 v228, 0, v14
    v_lshl_add_u32 v224, v228, 4, v15
    v_xor_b32 v228, 2, v14
    v_lshl_add_u32 v225, v228, 4, v15
    v_add_u32 v225, 1024, v225
    v_xor_b32 v228, 4, v14
    v_lshl_add_u32 v226, v228, 4, v15
    v_xor_b32 v228, 6, v14
    v_lshl_add_u32 v227, v228, 4, v15
    v_add_u32 v227, 1024, v227
    v_add_u32 v230, s52, v3
    v_mov_b32 v13, 0xff800000
    v_mov_b32 v231, 0xff800000
    v_cmp_eq_u32 s[54:55], 1, v6
    s_waitcnt vmcnt(0)
    v_and_b32 v228, 0xffff, v31
    v_cndmask_b32 v31, v31, v228, s[54:55]
    v_mov_b32 v192, 0
    v_mov_b32 v193, 0
    v_mov_b32 v194, 0
    v_mov_b32 v195, 0
    v_mov_b32 v196, 0
    v_mov_b32 v197, 0
    v_mov_b32 v198, 0
    v_mov_b32 v199, 0
    v_mov_b32 v200, 0
    v_mov_b32 v201, 0
    v_mov_b32 v202, 0
    v_mov_b32 v203, 0
    v_mov_b32 v204, 0
    v_mov_b32 v205, 0
    v_mov_b32 v206, 0
    v_mov_b32 v207, 0
    v_mov_b32 v208, 0
    v_mov_b32 v209, 0
    v_mov_b32 v210, 0
    v_mov_b32 v211, 0
    v_mov_b32 v212, 0
    v_mov_b32 v213, 0
    v_mov_b32 v214, 0
    v_mov_b32 v215, 0
    v_mov_b32 v216, 0
    v_mov_b32 v217, 0
    v_mov_b32 v218, 0
    v_mov_b32 v219, 0
    v_mov_b32 v220, 0
    v_mov_b32 v221, 0
    v_mov_b32 v222, 0
    v_mov_b32 v223, 0
    s_mov_b32 s56, 0
K2_XPASS:
    s_mov_b32 s53, 0
K2_XTILE:
    buffer_load_dwordx4 v[32:35], v3, s[76:79], s53 offen offset:0
    buffer_load_dwordx4 v[36:39], v3, s[76:79], s53 offen offset:1024
    buffer_load_dwordx4 v[40:43], v3, s[76:79], s53 offen offset:2048
    buffer_load_dwordx4 v[44:47], v3, s[76:79], s53 offen offset:3072
    s_waitcnt vmcnt(0)
    ds_write_b128 v230, v[32:35] offset:0
    ds_write_b128 v230, v[36:39] offset:1024
    ds_write_b128 v230, v[40:43] offset:2048
    ds_write_b128 v230, v[44:47] offset:3072
    s_waitcnt lgkmcnt(0)
    ds_read_b128 v[32:35], v232
    ds_read_b128 v[36:39], v233
    ds_read_b128 v[40:43], v234
    ds_read_b128 v[44:47], v235
    ds_read_b64_tr_b16 v[48:49], v224 offset:0
    ds_read_b64_tr_b16 v[50:51], v225 offset:0
    ds_read_b64_tr_b16 v[52:53], v226 offset:0
    ds_read_b64_tr_b16 v[54:55], v227 offset:0
    ds_read_b64_tr_b16 v[56:57], v224 offset:2048
    ds_read_b64_tr_b16 v[58:59], v225 offset:2048
    ds_read_b64_tr_b16 v[60:61], v226 offset:2048
    ds_read_b64_tr_b16 v[62:63], v227 offset:2048
    s_waitcnt lgkmcnt(0)
    v_mfma_f32_32x32x16_bf16 v[64:79], v[32:35], v[16:19], 0
    v_mfma_f32_32x32x16_bf16 v[64:79], v[36:39], v[20:23], v[64:79]
    v_mfma_f32_32x32x16_bf16 v[64:79], v[40:43], v[24:27], v[64:79]
    v_mfma_f32_32x32x16_bf16 v[64:79], v[44:47], v[28:31], v[64:79]
    s_nop 15
    s_cmp_lg_u32 s53, 1597440
    s_cbranch_scc1 K2_XNOMASK
    v_cndmask_b32 v72, v72, v231, s[54:55]
    v_cndmask_b32 v73, v73, v231, s[54:55]
    v_cndmask_b32 v74, v74, v231, s[54:55]
    v_cndmask_b32 v75, v75, v231, s[54:55]
    v_mov_b32 v76, v231
    v_mov_b32 v77, v231
    v_mov_b32 v78, v231
    v_mov_b32 v79, v231
K2_XNOMASK:
    s_cmp_lg_u32 s56, 0
    s_cbranch_scc1 K2_XP2
    v_max3_f32 v13, v13, v64, v65
    v_max3_f32 v13, v13, v66, v67
    v_max3_f32 v13, v13, v68, v69
    v_max3_f32 v13, v13, v70, v71
    v_max3_f32 v13, v13, v72, v73
    v_max3_f32 v13, v13, v74, v75
    v_max3_f32 v13, v13, v76, v77
    v_max3_f32 v13, v13, v78, v79
    s_branch K2_XNEXT
K2_XP2:
    v_sub_f32 v64, v64, v13
    v_sub_f32 v65, v65, v13
    v_sub_f32 v66, v66, v13
    v_sub_f32 v67, v67, v13
    v_sub_f32 v68, v68, v13
    v_sub_f32 v69, v69, v13
    v_sub_f32 v70, v70, v13
    v_sub_f32 v71, v71, v13
    v_sub_f32 v72, v72, v13
    v_sub_f32 v73, v73, v13
    v_sub_f32 v74, v74, v13
    v_sub_f32 v75, v75, v13
    v_sub_f32 v76, v76, v13
    v_sub_f32 v77, v77, v13
    v_sub_f32 v78, v78, v13
    v_sub_f32 v79, v79, v13
    v_exp_f32 v64, v64
    v_exp_f32 v65, v65
    v_exp_f32 v66, v66
    v_exp_f32 v67, v67
    v_exp_f32 v68, v68
    v_exp_f32 v69, v69
    v_exp_f32 v70, v70
    v_exp_f32 v71, v71
    v_exp_f32 v72, v72
    v_exp_f32 v73, v73
    v_exp_f32 v74, v74
    v_exp_f32 v75, v75
    v_exp_f32 v76, v76
    v_exp_f32 v77, v77
    v_exp_f32 v78, v78
    v_exp_f32 v79, v79
    v_cvt_pk_bf16_f32 v80, v64, v65
    v_cvt_pk_bf16_f32 v81, v66, v67
    v_cvt_pk_bf16_f32 v82, v68, v69
    v_cvt_pk_bf16_f32 v83, v70, v71
    v_cvt_pk_bf16_f32 v84, v72, v73
    v_cvt_pk_bf16_f32 v85, v74, v75
    v_cvt_pk_bf16_f32 v86, v76, v77
    v_cvt_pk_bf16_f32 v87, v78, v79
    v_mfma_f32_32x32x16_bf16 v[192:207], v[48:51], v[80:83], v[192:207]
    v_mfma_f32_32x32x16_bf16 v[208:223], v[52:55], v[80:83], v[208:223]
    v_mfma_f32_32x32x16_bf16 v[192:207], v[56:59], v[84:87], v[192:207]
    v_mfma_f32_32x32x16_bf16 v[208:223], v[60:63], v[84:87], v[208:223]
K2_XNEXT:
    s_add_u32 s53, s53, 0x1000
    s_cmp_lt_u32 s53, 1601536
    s_cbranch_scc1 K2_XTILE
    s_cmp_lg_u32 s56, 0
    s_cbranch_scc1 K2_XXDONE
    v_mov_b32 v228, v13
    s_nop 1
    v_permlane32_swap_b32 v13, v228
    v_max_f32 v13, v13, v228
    s_mov_b32 s56, 1
    s_branch K2_XPASS
K2_XXDONE:
    s_nop 15
    v_cvt_pk_bf16_f32 v32, v192, v193
    v_cvt_pk_bf16_f32 v33, v194, v195
    v_cvt_pk_bf16_f32 v34, v196, v197
    v_cvt_pk_bf16_f32 v35, v198, v199
    v_cvt_pk_bf16_f32 v36, v200, v201
    v_cvt_pk_bf16_f32 v37, v202, v203
    v_cvt_pk_bf16_f32 v38, v204, v205
    v_cvt_pk_bf16_f32 v39, v206, v207
    v_cvt_pk_bf16_f32 v40, v208, v209
    v_cvt_pk_bf16_f32 v41, v210, v211
    v_cvt_pk_bf16_f32 v42, v212, v213
    v_cvt_pk_bf16_f32 v43, v214, v215
    v_cvt_pk_bf16_f32 v44, v216, v217
    v_cvt_pk_bf16_f32 v45, v218, v219
    v_cvt_pk_bf16_f32 v46, v220, v221
    v_cvt_pk_bf16_f32 v47, v222, v223
    ds_write_b128 v230, v[32:35] offset:0
    ds_write_b128 v230, v[36:39] offset:1024
    ds_write_b128 v230, v[40:43] offset:2048
    ds_write_b128 v230, v[44:47] offset:3072
    ds_bpermute_b32 v152, v12, v223
    v_add_u32 v9, s52, v9
    s_waitcnt lgkmcnt(0)
    ds_read_b128 v[16:19], v9
    ds_read_b128 v[20:23], v9 offset:2048
    v_mov_b32 v24, 0
    v_mov_b32 v25, 0
    v_mov_b32 v26, 0
    v_mov_b32 v27, 0
    v_mov_b32 v28, 0
    v_mov_b32 v29, 0
    v_mov_b32 v30, 0
    v_mov_b32 v31, 0
    v_mov_b32 v32, 0
    v_mov_b32 v33, 0
    v_mov_b32 v34, 0
    v_mov_b32 v35, 0
    v_mov_b32 v36, 0
    v_mov_b32 v37, 0
    v_mov_b32 v38, 0
    v_mov_b32 v39, 0
    v_mov_b32 v40, 0
    v_mov_b32 v41, 0
    v_mov_b32 v42, 0
    v_mov_b32 v43, 0
    v_mov_b32 v44, 0
    v_mov_b32 v45, 0
    v_mov_b32 v46, 0
    v_mov_b32 v47, 0
    v_mov_b32 v48, 0
    v_mov_b32 v49, 0
    v_mov_b32 v50, 0
    v_mov_b32 v51, 0
    v_mov_b32 v52, 0
    v_mov_b32 v53, 0
    v_mov_b32 v54, 0
    v_mov_b32 v55, 0
    s_waitcnt lgkmcnt(0)
    s_branch K2_GO
K2_END:
    s_endpgm
.section .rodata,"a"
.p2align 6
.amdhsa_kernel prep_kernel
  .amdhsa_next_free_vgpr 128
  .amdhsa_next_free_sgpr 96
  .amdhsa_accum_offset 128
  .amdhsa_group_segment_fixed_size 0
  .amdhsa_kernarg_size 96
  .amdhsa_user_sgpr_count 2
  .amdhsa_user_sgpr_kernarg_segment_ptr 1
  .amdhsa_system_sgpr_workgroup_id_x 1
.end_amdhsa_kernel
.p2align 6
.amdhsa_kernel attn_kernel
  .amdhsa_next_free_vgpr 240
  .amdhsa_next_free_sgpr 102
  .amdhsa_accum_offset 240
  .amdhsa_group_segment_fixed_size 0
  .amdhsa_kernarg_size 96
  .amdhsa_user_sgpr_count 2
  .amdhsa_user_sgpr_kernarg_segment_ptr 1
  .amdhsa_system_sgpr_workgroup_id_x 1
.end_amdhsa_kernel
```
